```python
import torch

def _softmax(x, axis=-1):
    return torch.softmax(x, dim=axis)
def _gelu(x):
    return torch.nn.functional.gelu(x, approximate="tanh")
def _silu(x):
    return torch.nn.functional.silu(x)
def _sigmoid(x):
    return torch.sigmoid(x)
def _layernorm(x, axis=-1, eps=1e-5):
    m = x.mean(dim=axis, keepdim=True)
    v = x.var(dim=axis, keepdim=True, unbiased=False)
    return (x - m) / torch.sqrt(v + eps)
def _scatter_add(tgt, idx, src, axis=0):
    return tgt.clone().index_add_(axis, idx, src)
def _segment_sum(src, seg, n):
    out = torch.zeros((n,) + src.shape[1:], dtype=src.dtype)
    return out.index_add_(0, seg, src)
def _pad(x, pw):
    flat = tuple(v for pair in reversed(pw) for v in pair)
    return torch.nn.functional.pad(x, flat)

kernel_name = 'standalone__mha_block_cached__near_ridge'

def setup_inputs():

    _w = (lambda a: (lambda t: t.to(torch.bfloat16) if t.is_floating_point() else t)(torch.as_tensor(a)))
    B, Sq, D = 8, 128, 448
    H, Sk, Dh = 16, 512, 256
    return {
        "x": _w((lambda *s: torch.randn(*s, dtype=torch.bfloat16) * 0.8)(B, Sq, D)),
        "k_cache": _w((lambda *s: torch.randn(*s, dtype=torch.bfloat16) * 0.8)(B, H, Sk, Dh)),
        "v_cache": _w((lambda *s: torch.randn(*s, dtype=torch.bfloat16) * 0.05)(B, H, Sk, Dh)),
        "wq": _w((lambda *s: torch.randn(*s, dtype=torch.bfloat16) * 0.8)(D, H * Dh) * (D ** -0.5)),
        "wo": _w((lambda *s: torch.randn(*s, dtype=torch.bfloat16) * 0.05)(H * Dh, D) * ((H * Dh) ** -0.5)),
    }

def reference(x, k_cache, v_cache, wq, wo):
    B, Sq, D = x.shape
    H, Dh = 16, 256
    q = (lambda x, *d: x.permute(*d))((x @ wq).reshape(B, Sq, H, Dh), 0, 2, 1, 3)
    scores = torch.einsum("bhqd,bhkd->bhqk", q, k_cache) * (Dh ** -0.5)
    p = _softmax(scores, axis=-1)
    o = torch.einsum("bhqk,bhkd->bhqd", p, v_cache)
    return (lambda x, *d: x.permute(*d))(o, 0, 2, 1, 3).reshape(B, Sq, H * Dh) @ wo
```

```asm
; @launch kernel=attn_kernel grid=(256,1,1) block=(512,1,1) lds=163840
; @launch kernel=reduce_kernel grid=(224,1,1) block=(256,1,1) lds=0
.amdgcn_target "amdgcn-amd-amdhsa--gfx950"
.text
.globl attn_kernel
.p2align 8
.type attn_kernel,@function
attn_kernel:
    s_cmp_ge_u32 s2, 256
    s_cbranch_scc1 attn_end
    s_load_dwordx8 s[36:43], s[0:1], 0
    s_load_dwordx2 s[44:45], s[0:1], 32
    s_load_dwordx2 s[46:47], s[0:1], 56
    v_and_b32 v1, 63, v0
    v_lshrrev_b32 v32, 6, v0
    s_nop 0
    v_readfirstlane_b32 s49, v32
    s_and_b32 s3, s2, 7
    s_lshr_b32 s33, s2, 3
    s_lshr_b32 s32, s33, 2
    s_lshr_b32 s31, s33, 1
    s_and_b32 s31, s31, 1
    s_and_b32 s33, s33, 1
    s_lshl_b32 s3, s3, 1
    s_add_u32 s31, s31, s3
    s_and_b32 s28, s49, 3
    s_lshr_b32 s29, s28, 1
    s_and_b32 s30, s28, 1
    s_lshl_b32 s34, s28, 10
    s_mov_b32 s35, s30
    s_lshl_b32 s3, s32, 1
    s_add_u32 s3, s3, s33
    s_mul_i32 s48, s3, 37
    s_lshr_b32 s48, s48, 8
    s_mul_i32 s48, s48, 7
    s_sub_u32 s97, s3, s48
    s_sub_u32 s48, s3, 14
    s_cmp_ge_u32 s3, 14
    s_cselect_b32 s98, s48, s3
    s_lshl_b32 s3, s33, 17
    s_mov_b32 s3, 0
    s_add_u32 s95, s34, s3
    s_sub_u32 s96, s34, s3
    s_cmp_ge_u32 s49, 4
    s_waitcnt lgkmcnt(0)
    s_cbranch_scc1 attn_loader
    s_lshl_b32 s3, s31, 4
    s_lshl_b32 s48, s32, 1
    s_add_u32 s3, s3, s48
    s_add_u32 s3, s3, s33
    s_lshl_b32 s3, s3, 2
    s_add_u32 s3, s3, s28
    s_mul_i32 s3, s3, 14336
    s_add_u32 s24, s46, s3
    s_addc_u32 s25, s47, 0
    s_and_b32 s25, s25, 0xffff
    s_mov_b32 s26, 14336
    s_mov_b32 s27, 0x20000
    s_mov_b32 s50, 0x3db8aa3b
    s_mov_b32 s42, 0x3db8aa3b
    s_mov_b32 s44, 0xbdb8aa3b
    s_mov_b32 s43, 0x3db8aa3b
    s_lshl_b32 s3, s32, 1
    s_add_u32 s3, s3, s33
    s_mul_i32 s3, s3, 57344
    s_add_u32 s4, s36, s3
    s_addc_u32 s5, s37, 0
    s_and_b32 s5, s5, 0xffff
    s_mov_b32 s6, 57344
    s_mov_b32 s7, 0x20000
    s_lshl_b32 s3, s32, 4
    s_add_u32 s3, s3, s31
    s_lshl_b32 s3, s3, 18
    s_add_u32 s8, s38, s3
    s_addc_u32 s9, s39, 0
    s_and_b32 s9, s9, 0xffff
    s_mov_b32 s10, 262144
    s_mov_b32 s11, 0x20000
    s_mul_i32 s36, s28, 896
    v_mov_b32 v74, 0x40000000
    s_add_u32 s3, s28, 0
    v_xor_b32 v72, s3, v1
    v_lshlrev_b32 v73, 4, v72
    v_cmp_gt_u32 vcc, 56, v72
    s_nop 1
    v_cndmask_b32 v64, v74, v73, vcc
    s_add_u32 s3, s28, 4
    v_xor_b32 v72, s3, v1
    v_lshlrev_b32 v73, 4, v72
    v_cmp_gt_u32 vcc, 56, v72
    s_nop 1
    v_cndmask_b32 v65, v74, v73, vcc
    s_add_u32 s3, s28, 8
    v_xor_b32 v72, s3, v1
    v_lshlrev_b32 v73, 4, v72
    v_cmp_gt_u32 vcc, 56, v72
    s_nop 1
    v_cndmask_b32 v66, v74, v73, vcc
    s_add_u32 s3, s28, 12
    v_xor_b32 v72, s3, v1
    v_lshlrev_b32 v73, 4, v72
    v_cmp_gt_u32 vcc, 56, v72
    s_nop 1
    v_cndmask_b32 v67, v74, v73, vcc
    v_lshrrev_b32 v72, 5, v1
    v_and_b32 v73, 31, v1
    v_xor_b32 v73, v73, v72
    v_lshlrev_b32 v73, 4, v73
    v_lshl_add_u32 v73, v72, 9, v73
    s_lshl_b32 s3, s28, 5
    v_xor_b32 v68, s3, v73
    v_xor_b32 v69, 0x80, v68
    s_add_u32 m0, s34, 0
    s_add_u32 s3, s36, 0
    buffer_load_dwordx4 v64, s[4:7], s3 offen lds
    s_add_u32 m0, s34, 4096
    s_add_u32 s3, s36, 3584
    buffer_load_dwordx4 v65, s[4:7], s3 offen lds
    s_add_u32 m0, s34, 16384
    s_add_u32 s3, s36, 14336
    buffer_load_dwordx4 v64, s[4:7], s3 offen lds
    s_add_u32 m0, s34, 20480
    s_add_u32 s3, s36, 17920
    buffer_load_dwordx4 v65, s[4:7], s3 offen lds
    s_add_u32 m0, s34, 32768
    s_add_u32 s3, s36, 28672
    buffer_load_dwordx4 v64, s[4:7], s3 offen lds
    s_add_u32 m0, s34, 36864
    s_add_u32 s3, s36, 32256
    buffer_load_dwordx4 v65, s[4:7], s3 offen lds
    s_add_u32 m0, s34, 49152
    s_add_u32 s3, s36, 43008
    buffer_load_dwordx4 v64, s[4:7], s3 offen lds
    s_add_u32 m0, s34, 53248
    s_add_u32 s3, s36, 46592
    buffer_load_dwordx4 v65, s[4:7], s3 offen lds
    v_lshrrev_b32 v32, 5, v1
    v_and_b32 v33, 31, v1
    v_lshlrev_b32 v30, 4, v1
    v_and_b32 v34, 15, v33
    v_xor_b32 v34, v34, v32
    v_lshlrev_b32 v2, 4, v34
    s_lshl_b32 s3, s29, 15
    v_lshl_add_u32 v3, v33, 10, s3
    v_bfe_u32 v34, v1, 2, 2
    v_bfe_u32 v36, v1, 4, 1
    v_and_b32 v37, 1, v1
    v_bfe_u32 v38, v1, 1, 1
    v_lshlrev_b32 v36, 2, v36
    v_lshlrev_b32 v37, 1, v37
    v_or3_b32 v35, v36, v37, v38
    v_lshlrev_b32 v35, 3, v35
    v_lshl_add_u32 v36, v32, 3, v34
    v_lshl_add_u32 v37, v36, 9, v35
    v_lshl_add_u32 v37, v34, 6, v37
    s_lshl_b32 s48, s30, 8
    v_add_u32 v38, s48, v37
    s_xor_b32 s48, s48, 256
    v_add_u32 v39, s48, v37
    v_xor_b32 v10, 0, v38
    v_xor_b32 v14, 0, v39
    v_xor_b32 v18, 0, v38
    v_xor_b32 v11, 64, v38
    v_xor_b32 v15, 64, v39
    v_xor_b32 v19, 64, v38
    v_xor_b32 v12, 128, v38
    v_xor_b32 v16, 128, v39
    v_xor_b32 v20, 128, v38
    v_xor_b32 v13, 192, v38
    v_xor_b32 v17, 192, v39
    v_xor_b32 v21, 192, v38
    v_lshl_add_u32 v37, v36, 7, v35
    v_lshrrev_b32 v38, 1, v34
    v_xor_b32 v38, s30, v38
    v_lshl_add_u32 v22, v38, 6, v37
    s_lshl_b32 s37, s98, 1
    s_add_u32 s3, s37, 0
    s_sub_u32 s48, s3, 28
    s_cmp_ge_u32 s3, 28
    s_cselect_b32 s3, s48, s3
    s_lshl_b32 s3, s3, 5
    v_xor_b32 v176, s3, v2
    v_add_u32 v176, v176, v3
    s_add_u32 s3, s37, 1
    s_sub_u32 s48, s3, 28
    s_cmp_ge_u32 s3, 28
    s_cselect_b32 s3, s48, s3
    s_lshl_b32 s3, s3, 5
    v_xor_b32 v177, s3, v2
    v_add_u32 v177, v177, v3
    s_add_u32 s3, s37, 2
    s_sub_u32 s48, s3, 28
    s_cmp_ge_u32 s3, 28
    s_cselect_b32 s3, s48, s3
    s_lshl_b32 s3, s3, 5
    v_xor_b32 v178, s3, v2
    v_add_u32 v178, v178, v3
    s_add_u32 s3, s37, 3
    s_sub_u32 s48, s3, 28
    s_cmp_ge_u32 s3, 28
    s_cselect_b32 s3, s48, s3
    s_lshl_b32 s3, s3, 5
    v_xor_b32 v179, s3, v2
    v_add_u32 v179, v179, v3
    s_add_u32 s3, s37, 4
    s_sub_u32 s48, s3, 28
    s_cmp_ge_u32 s3, 28
    s_cselect_b32 s3, s48, s3
    s_lshl_b32 s3, s3, 5
    v_xor_b32 v180, s3, v2
    v_add_u32 v180, v180, v3
    s_add_u32 s3, s37, 5
    s_sub_u32 s48, s3, 28
    s_cmp_ge_u32 s3, 28
    s_cselect_b32 s3, s48, s3
    s_lshl_b32 s3, s3, 5
    v_xor_b32 v181, s3, v2
    v_add_u32 v181, v181, v3
    s_add_u32 s3, s37, 6
    s_sub_u32 s48, s3, 28
    s_cmp_ge_u32 s3, 28
    s_cselect_b32 s3, s48, s3
    s_lshl_b32 s3, s3, 5
    v_xor_b32 v182, s3, v2
    v_add_u32 v182, v182, v3
    s_add_u32 s3, s37, 7
    s_sub_u32 s48, s3, 28
    s_cmp_ge_u32 s3, 28
    s_cselect_b32 s3, s48, s3
    s_lshl_b32 s3, s3, 5
    v_xor_b32 v183, s3, v2
    v_add_u32 v183, v183, v3
    s_add_u32 s3, s37, 8
    s_sub_u32 s48, s3, 28
    s_cmp_ge_u32 s3, 28
    s_cselect_b32 s3, s48, s3
    s_lshl_b32 s3, s3, 5
    v_xor_b32 v184, s3, v2
    v_add_u32 v184, v184, v3
    s_add_u32 s3, s37, 9
    s_sub_u32 s48, s3, 28
    s_cmp_ge_u32 s3, 28
    s_cselect_b32 s3, s48, s3
    s_lshl_b32 s3, s3, 5
    v_xor_b32 v185, s3, v2
    v_add_u32 v185, v185, v3
    s_add_u32 s3, s37, 10
    s_sub_u32 s48, s3, 28
    s_cmp_ge_u32 s3, 28
    s_cselect_b32 s3, s48, s3
    s_lshl_b32 s3, s3, 5
    v_xor_b32 v186, s3, v2
    v_add_u32 v186, v186, v3
    s_add_u32 s3, s37, 11
    s_sub_u32 s48, s3, 28
    s_cmp_ge_u32 s3, 28
    s_cselect_b32 s3, s48, s3
    s_lshl_b32 s3, s3, 5
    v_xor_b32 v187, s3, v2
    v_add_u32 v187, v187, v3
    s_add_u32 s3, s37, 12
    s_sub_u32 s48, s3, 28
    s_cmp_ge_u32 s3, 28
    s_cselect_b32 s3, s48, s3
    s_lshl_b32 s3, s3, 5
    v_xor_b32 v188, s3, v2
    v_add_u32 v188, v188, v3
    s_add_u32 s3, s37, 13
    s_sub_u32 s48, s3, 28
    s_cmp_ge_u32 s3, 28
    s_cselect_b32 s3, s48, s3
    s_lshl_b32 s3, s3, 5
    v_xor_b32 v189, s3, v2
    v_add_u32 v189, v189, v3
    s_add_u32 s3, s37, 14
    s_sub_u32 s48, s3, 28
    s_cmp_ge_u32 s3, 28
    s_cselect_b32 s3, s48, s3
    s_lshl_b32 s3, s3, 5
    v_xor_b32 v190, s3, v2
    v_add_u32 v190, v190, v3
    s_add_u32 s3, s37, 15
    s_sub_u32 s48, s3, 28
    s_cmp_ge_u32 s3, 28
    s_cselect_b32 s3, s48, s3
    s_lshl_b32 s3, s3, 5
    v_xor_b32 v191, s3, v2
    v_add_u32 v191, v191, v3
    s_add_u32 s3, s37, 16
    s_sub_u32 s48, s3, 28
    s_cmp_ge_u32 s3, 28
    s_cselect_b32 s3, s48, s3
    s_lshl_b32 s3, s3, 5
    v_xor_b32 v192, s3, v2
    v_add_u32 v192, v192, v3
    s_add_u32 s3, s37, 17
    s_sub_u32 s48, s3, 28
    s_cmp_ge_u32 s3, 28
    s_cselect_b32 s3, s48, s3
    s_lshl_b32 s3, s3, 5
    v_xor_b32 v193, s3, v2
    v_add_u32 v193, v193, v3
    s_add_u32 s3, s37, 18
    s_sub_u32 s48, s3, 28
    s_cmp_ge_u32 s3, 28
    s_cselect_b32 s3, s48, s3
    s_lshl_b32 s3, s3, 5
    v_xor_b32 v194, s3, v2
    v_add_u32 v194, v194, v3
    s_add_u32 s3, s37, 19
    s_sub_u32 s48, s3, 28
    s_cmp_ge_u32 s3, 28
    s_cselect_b32 s3, s48, s3
    s_lshl_b32 s3, s3, 5
    v_xor_b32 v195, s3, v2
    v_add_u32 v195, v195, v3
    s_add_u32 s3, s37, 20
    s_sub_u32 s48, s3, 28
    s_cmp_ge_u32 s3, 28
    s_cselect_b32 s3, s48, s3
    s_lshl_b32 s3, s3, 5
    v_xor_b32 v196, s3, v2
    v_add_u32 v196, v196, v3
    s_add_u32 s3, s37, 21
    s_sub_u32 s48, s3, 28
    s_cmp_ge_u32 s3, 28
    s_cselect_b32 s3, s48, s3
    s_lshl_b32 s3, s3, 5
    v_xor_b32 v197, s3, v2
    v_add_u32 v197, v197, v3
    s_add_u32 s3, s37, 22
    s_sub_u32 s48, s3, 28
    s_cmp_ge_u32 s3, 28
    s_cselect_b32 s3, s48, s3
    s_lshl_b32 s3, s3, 5
    v_xor_b32 v198, s3, v2
    v_add_u32 v198, v198, v3
    s_add_u32 s3, s37, 23
    s_sub_u32 s48, s3, 28
    s_cmp_ge_u32 s3, 28
    s_cselect_b32 s3, s48, s3
    s_lshl_b32 s3, s3, 5
    v_xor_b32 v199, s3, v2
    v_add_u32 v199, v199, v3
    s_add_u32 s3, s37, 24
    s_sub_u32 s48, s3, 28
    s_cmp_ge_u32 s3, 28
    s_cselect_b32 s3, s48, s3
    s_lshl_b32 s3, s3, 5
    v_xor_b32 v200, s3, v2
    v_add_u32 v200, v200, v3
    s_add_u32 s3, s37, 25
    s_sub_u32 s48, s3, 28
    s_cmp_ge_u32 s3, 28
    s_cselect_b32 s3, s48, s3
    s_lshl_b32 s3, s3, 5
    v_xor_b32 v201, s3, v2
    v_add_u32 v201, v201, v3
    s_add_u32 s3, s37, 26
    s_sub_u32 s48, s3, 28
    s_cmp_ge_u32 s3, 28
    s_cselect_b32 s3, s48, s3
    s_lshl_b32 s3, s3, 5
    v_xor_b32 v202, s3, v2
    v_add_u32 v202, v202, v3
    s_add_u32 s3, s37, 27
    s_sub_u32 s48, s3, 28
    s_cmp_ge_u32 s3, 28
    s_cselect_b32 s3, s48, s3
    s_lshl_b32 s3, s3, 5
    v_xor_b32 v203, s3, v2
    v_add_u32 v203, v203, v3
    s_waitcnt vmcnt(0)
    s_barrier
    ds_read_b128 v[64:67], v176
    ds_read_b128 v[68:71], v177
    ds_read_b128 v[72:75], v178
    ds_read_b128 v[76:79], v179
    ds_read_b128 v[80:83], v180
    ds_read_b128 v[84:87], v181
    ds_read_b128 v[88:91], v182
    ds_read_b128 v[92:95], v183
    ds_read_b128 v[96:99], v184
    ds_read_b128 v[100:103], v185
    ds_read_b128 v[104:107], v186
    ds_read_b128 v[108:111], v187
    ds_read_b128 v[112:115], v188
    ds_read_b128 v[116:119], v189
    s_waitcnt lgkmcnt(2)
    ds_read_b128 v[120:123], v190
    ds_read_b128 v[124:127], v191
    ds_read_b128 v[128:131], v192
    ds_read_b128 v[132:135], v193
    ds_read_b128 v[136:139], v194
    ds_read_b128 v[140:143], v195
    ds_read_b128 v[144:147], v196
    ds_read_b128 v[148:151], v197
    ds_read_b128 v[152:155], v198
    ds_read_b128 v[156:159], v199
    ds_read_b128 v[160:163], v200
    ds_read_b128 v[164:167], v201
    s_waitcnt lgkmcnt(2)
    ds_read_b128 v[168:171], v202
    ds_read_b128 v[172:175], v203
    v_and_b32 v34, 0x13, v33
    v_and_b32 v35, 8, v33
    v_lshrrev_b32 v35, 1, v35
    v_and_b32 v36, 4, v33
    v_lshlrev_b32 v36, 1, v36
    v_or3_b32 v34, v34, v35, v36
    v_and_b32 v35, 15, v34
    v_xor_b32 v35, v35, v32
    v_lshlrev_b32 v35, 4, v35
    v_lshl_add_u32 v34, v34, 9, v35
    v_xor_b32 v2, 0, v34
    v_xor_b32 v3, 32, v34
    v_xor_b32 v4, 64, v34
    v_xor_b32 v5, 96, v34
    v_xor_b32 v6, 128, v34
    v_xor_b32 v7, 160, v34
    v_xor_b32 v8, 192, v34
    v_xor_b32 v9, 224, v34
    s_waitcnt lgkmcnt(0)
    s_barrier
    s_mov_b32 s3, 65536
    v_add_u32 v18, s3, v18
    v_add_u32 v19, s3, v19
    v_add_u32 v20, s3, v20
    v_add_u32 v21, s3, v21
    ds_read_b64_tr_b16 v[40:41], v18 offset:0
    ds_read_b64_tr_b16 v[42:43], v18 offset:2048
    ds_read_b64_tr_b16 v[44:45], v19 offset:0
    ds_read_b64_tr_b16 v[46:47], v19 offset:2048
    ds_read_b64_tr_b16 v[48:49], v20 offset:0
    ds_read_b64_tr_b16 v[50:51], v20 offset:2048
    ds_read_b64_tr_b16 v[52:53], v21 offset:0
    ds_read_b64_tr_b16 v[54:55], v21 offset:2048
    ds_read_b64_tr_b16 v[56:57], v18 offset:8192
    ds_read_b64_tr_b16 v[58:59], v18 offset:10240
    ds_read_b64_tr_b16 v[60:61], v19 offset:8192
    ds_read_b64_tr_b16 v[62:63], v19 offset:10240
    s_waitcnt lgkmcnt(10)
    v_mfma_f32_32x32x16_bf16 v[176:191], v[40:43], v[64:67], 0
    ds_read_b64_tr_b16 v[40:41], v20 offset:8192
    ds_read_b64_tr_b16 v[42:43], v20 offset:10240
    s_waitcnt lgkmcnt(10)
    v_mfma_f32_32x32x16_bf16 v[192:207], v[44:47], v[64:67], 0
    ds_read_b64_tr_b16 v[44:45], v21 offset:8192
    ds_read_b64_tr_b16 v[46:47], v21 offset:10240
    s_waitcnt lgkmcnt(10)
    v_mfma_f32_32x32x16_bf16 v[208:223], v[48:51], v[64:67], 0
    s_barrier
    ds_read_b64_tr_b16 v[48:49], v18 offset:16384
    ds_read_b64_tr_b16 v[50:51], v18 offset:18432
    s_waitcnt lgkmcnt(10)
    v_mfma_f32_32x32x16_bf16 v[224:239], v[52:55], v[64:67], 0
    ds_read_b64_tr_b16 v[52:53], v19 offset:16384
    ds_read_b64_tr_b16 v[54:55], v19 offset:18432
    s_waitcnt lgkmcnt(10)
    v_mfma_f32_32x32x16_bf16 v[176:191], v[56:59], v[68:71], v[176:191]
    ds_read_b64_tr_b16 v[56:57], v20 offset:16384
    ds_read_b64_tr_b16 v[58:59], v20 offset:18432
    s_waitcnt lgkmcnt(10)
    v_mfma_f32_32x32x16_bf16 v[192:207], v[60:63], v[68:71], v[192:207]
    ds_read_b64_tr_b16 v[60:61], v21 offset:16384
    ds_read_b64_tr_b16 v[62:63], v21 offset:18432
    s_waitcnt lgkmcnt(10)
    v_mfma_f32_32x32x16_bf16 v[208:223], v[40:43], v[68:71], v[208:223]
    ds_read_b64_tr_b16 v[40:41], v18 offset:24576
    ds_read_b64_tr_b16 v[42:43], v18 offset:26624
    s_waitcnt lgkmcnt(10)
    v_mfma_f32_32x32x16_bf16 v[224:239], v[44:47], v[68:71], v[224:239]
    ds_read_b64_tr_b16 v[44:45], v19 offset:24576
    ds_read_b64_tr_b16 v[46:47], v19 offset:26624
    s_waitcnt lgkmcnt(10)
    v_mfma_f32_32x32x16_bf16 v[176:191], v[48:51], v[72:75], v[176:191]
    ds_read_b64_tr_b16 v[48:49], v20 offset:24576
    ds_read_b64_tr_b16 v[50:51], v20 offset:26624
    s_waitcnt lgkmcnt(10)
    v_mfma_f32_32x32x16_bf16 v[192:207], v[52:55], v[72:75], v[192:207]
    ds_read_b64_tr_b16 v[52:53], v21 offset:24576
    ds_read_b64_tr_b16 v[54:55], v21 offset:26624
    s_waitcnt lgkmcnt(10)
    v_mfma_f32_32x32x16_bf16 v[208:223], v[56:59], v[72:75], v[208:223]
    s_barrier
    ds_read_b64_tr_b16 v[56:57], v18 offset:32768
    ds_read_b64_tr_b16 v[58:59], v18 offset:34816
    s_waitcnt lgkmcnt(10)
    v_mfma_f32_32x32x16_bf16 v[224:239], v[60:63], v[72:75], v[224:239]
    ds_read_b64_tr_b16 v[60:61], v19 offset:32768
    ds_read_b64_tr_b16 v[62:63], v19 offset:34816
    s_waitcnt lgkmcnt(10)
    v_mfma_f32_32x32x16_bf16 v[176:191], v[40:43], v[76:79], v[176:191]
    ds_read_b64_tr_b16 v[40:41], v20 offset:32768
    ds_read_b64_tr_b16 v[42:43], v20 offset:34816
    s_waitcnt lgkmcnt(10)
    v_mfma_f32_32x32x16_bf16 v[192:207], v[44:47], v[76:79], v[192:207]
    ds_read_b64_tr_b16 v[44:45], v21 offset:32768
    ds_read_b64_tr_b16 v[46:47], v21 offset:34816
    s_waitcnt lgkmcnt(10)
    v_mfma_f32_32x32x16_bf16 v[208:223], v[48:51], v[76:79], v[208:223]
    ds_read_b64_tr_b16 v[48:49], v18 offset:40960
    ds_read_b64_tr_b16 v[50:51], v18 offset:43008
    s_waitcnt lgkmcnt(10)
    v_mfma_f32_32x32x16_bf16 v[224:239], v[52:55], v[76:79], v[224:239]
    ds_read_b64_tr_b16 v[52:53], v19 offset:40960
    ds_read_b64_tr_b16 v[54:55], v19 offset:43008
    s_waitcnt lgkmcnt(10)
    v_mfma_f32_32x32x16_bf16 v[176:191], v[56:59], v[80:83], v[176:191]
    ds_read_b64_tr_b16 v[56:57], v20 offset:40960
    ds_read_b64_tr_b16 v[58:59], v20 offset:43008
    s_waitcnt lgkmcnt(10)
    v_mfma_f32_32x32x16_bf16 v[192:207], v[60:63], v[80:83], v[192:207]
    ds_read_b64_tr_b16 v[60:61], v21 offset:40960
    ds_read_b64_tr_b16 v[62:63], v21 offset:43008
    s_waitcnt lgkmcnt(10)
    v_mfma_f32_32x32x16_bf16 v[208:223], v[40:43], v[80:83], v[208:223]
    s_barrier
    ds_read_b64_tr_b16 v[40:41], v18 offset:49152
    ds_read_b64_tr_b16 v[42:43], v18 offset:51200
    s_waitcnt lgkmcnt(10)
    v_mfma_f32_32x32x16_bf16 v[224:239], v[44:47], v[80:83], v[224:239]
    ds_read_b64_tr_b16 v[44:45], v19 offset:49152
    ds_read_b64_tr_b16 v[46:47], v19 offset:51200
    s_waitcnt lgkmcnt(10)
    v_mfma_f32_32x32x16_bf16 v[176:191], v[48:51], v[84:87], v[176:191]
    ds_read_b64_tr_b16 v[48:49], v20 offset:49152
    ds_read_b64_tr_b16 v[50:51], v20 offset:51200
    s_waitcnt lgkmcnt(10)
    v_mfma_f32_32x32x16_bf16 v[192:207], v[52:55], v[84:87], v[192:207]
    ds_read_b64_tr_b16 v[52:53], v21 offset:49152
    ds_read_b64_tr_b16 v[54:55], v21 offset:51200
    s_waitcnt lgkmcnt(10)
    v_mfma_f32_32x32x16_bf16 v[208:223], v[56:59], v[84:87], v[208:223]
    ds_read_b64_tr_b16 v[56:57], v18 offset:57344
    ds_read_b64_tr_b16 v[58:59], v18 offset:59392
    s_waitcnt lgkmcnt(10)
    v_mfma_f32_32x32x16_bf16 v[224:239], v[60:63], v[84:87], v[224:239]
    ds_read_b64_tr_b16 v[60:61], v19 offset:57344
    ds_read_b64_tr_b16 v[62:63], v19 offset:59392
    s_waitcnt lgkmcnt(10)
    v_mfma_f32_32x32x16_bf16 v[176:191], v[40:43], v[88:91], v[176:191]
    ds_read_b64_tr_b16 v[40:41], v20 offset:57344
    ds_read_b64_tr_b16 v[42:43], v20 offset:59392
    s_waitcnt lgkmcnt(10)
    v_mfma_f32_32x32x16_bf16 v[192:207], v[44:47], v[88:91], v[192:207]
    ds_read_b64_tr_b16 v[44:45], v21 offset:57344
    ds_read_b64_tr_b16 v[46:47], v21 offset:59392
    s_waitcnt lgkmcnt(10)
    v_mfma_f32_32x32x16_bf16 v[208:223], v[48:51], v[88:91], v[208:223]
    s_barrier
    s_mov_b32 s3, 4294901760
    v_add_u32 v18, s3, v18
    v_add_u32 v19, s3, v19
    v_add_u32 v20, s3, v20
    v_add_u32 v21, s3, v21
    ds_read_b64_tr_b16 v[48:49], v18 offset:0
    ds_read_b64_tr_b16 v[50:51], v18 offset:2048
    s_waitcnt lgkmcnt(10)
    v_mfma_f32_32x32x16_bf16 v[224:239], v[52:55], v[88:91], v[224:239]
    ds_read_b64_tr_b16 v[52:53], v19 offset:0
    ds_read_b64_tr_b16 v[54:55], v19 offset:2048
    s_waitcnt lgkmcnt(10)
    v_mfma_f32_32x32x16_bf16 v[176:191], v[56:59], v[92:95], v[176:191]
    ds_read_b64_tr_b16 v[56:57], v20 offset:0
    ds_read_b64_tr_b16 v[58:59], v20 offset:2048
    s_waitcnt lgkmcnt(10)
    v_mfma_f32_32x32x16_bf16 v[192:207], v[60:63], v[92:95], v[192:207]
    ds_read_b64_tr_b16 v[60:61], v21 offset:0
    ds_read_b64_tr_b16 v[62:63], v21 offset:2048
    s_waitcnt lgkmcnt(10)
    v_mfma_f32_32x32x16_bf16 v[208:223], v[40:43], v[92:95], v[208:223]
    ds_read_b64_tr_b16 v[40:41], v18 offset:8192
    ds_read_b64_tr_b16 v[42:43], v18 offset:10240
    s_waitcnt lgkmcnt(10)
    v_mfma_f32_32x32x16_bf16 v[224:239], v[44:47], v[92:95], v[224:239]
    ds_read_b64_tr_b16 v[44:45], v19 offset:8192
    ds_read_b64_tr_b16 v[46:47], v19 offset:10240
    s_waitcnt lgkmcnt(10)
    v_mfma_f32_32x32x16_bf16 v[176:191], v[48:51], v[96:99], v[176:191]
    ds_read_b64_tr_b16 v[48:49], v20 offset:8192
    ds_read_b64_tr_b16 v[50:51], v20 offset:10240
    s_waitcnt lgkmcnt(10)
    v_mfma_f32_32x32x16_bf16 v[192:207], v[52:55], v[96:99], v[192:207]
    ds_read_b64_tr_b16 v[52:53], v21 offset:8192
    ds_read_b64_tr_b16 v[54:55], v21 offset:10240
    s_waitcnt lgkmcnt(10)
    v_mfma_f32_32x32x16_bf16 v[208:223], v[56:59], v[96:99], v[208:223]
    s_barrier
    ds_read_b64_tr_b16 v[56:57], v18 offset:16384
    ds_read_b64_tr_b16 v[58:59], v18 offset:18432
    s_waitcnt lgkmcnt(10)
    v_mfma_f32_32x32x16_bf16 v[224:239], v[60:63], v[96:99], v[224:239]
    ds_read_b64_tr_b16 v[60:61], v19 offset:16384
    ds_read_b64_tr_b16 v[62:63], v19 offset:18432
    s_waitcnt lgkmcnt(10)
    v_mfma_f32_32x32x16_bf16 v[176:191], v[40:43], v[100:103], v[176:191]
    ds_read_b64_tr_b16 v[40:41], v20 offset:16384
    ds_read_b64_tr_b16 v[42:43], v20 offset:18432
    s_waitcnt lgkmcnt(10)
    v_mfma_f32_32x32x16_bf16 v[192:207], v[44:47], v[100:103], v[192:207]
    ds_read_b64_tr_b16 v[44:45], v21 offset:16384
    ds_read_b64_tr_b16 v[46:47], v21 offset:18432
    s_waitcnt lgkmcnt(10)
    v_mfma_f32_32x32x16_bf16 v[208:223], v[48:51], v[100:103], v[208:223]
    ds_read_b64_tr_b16 v[48:49], v18 offset:24576
    ds_read_b64_tr_b16 v[50:51], v18 offset:26624
    s_waitcnt lgkmcnt(10)
    v_mfma_f32_32x32x16_bf16 v[224:239], v[52:55], v[100:103], v[224:239]
    ds_read_b64_tr_b16 v[52:53], v19 offset:24576
    ds_read_b64_tr_b16 v[54:55], v19 offset:26624
    s_waitcnt lgkmcnt(10)
    v_mfma_f32_32x32x16_bf16 v[176:191], v[56:59], v[104:107], v[176:191]
    ds_read_b64_tr_b16 v[56:57], v20 offset:24576
    ds_read_b64_tr_b16 v[58:59], v20 offset:26624
    s_waitcnt lgkmcnt(10)
    v_mfma_f32_32x32x16_bf16 v[192:207], v[60:63], v[104:107], v[192:207]
    ds_read_b64_tr_b16 v[60:61], v21 offset:24576
    ds_read_b64_tr_b16 v[62:63], v21 offset:26624
    s_waitcnt lgkmcnt(10)
    v_mfma_f32_32x32x16_bf16 v[208:223], v[40:43], v[104:107], v[208:223]
    s_barrier
    ds_read_b64_tr_b16 v[40:41], v18 offset:32768
    ds_read_b64_tr_b16 v[42:43], v18 offset:34816
    s_waitcnt lgkmcnt(10)
    v_mfma_f32_32x32x16_bf16 v[224:239], v[44:47], v[104:107], v[224:239]
    ds_read_b64_tr_b16 v[44:45], v19 offset:32768
    ds_read_b64_tr_b16 v[46:47], v19 offset:34816
    s_waitcnt lgkmcnt(10)
    v_mfma_f32_32x32x16_bf16 v[176:191], v[48:51], v[108:111], v[176:191]
    ds_read_b64_tr_b16 v[48:49], v20 offset:32768
    ds_read_b64_tr_b16 v[50:51], v20 offset:34816
    s_waitcnt lgkmcnt(10)
    v_mfma_f32_32x32x16_bf16 v[192:207], v[52:55], v[108:111], v[192:207]
    ds_read_b64_tr_b16 v[52:53], v21 offset:32768
    ds_read_b64_tr_b16 v[54:55], v21 offset:34816
    s_waitcnt lgkmcnt(10)
    v_mfma_f32_32x32x16_bf16 v[208:223], v[56:59], v[108:111], v[208:223]
    ds_read_b64_tr_b16 v[56:57], v18 offset:40960
    ds_read_b64_tr_b16 v[58:59], v18 offset:43008
    s_waitcnt lgkmcnt(10)
    v_mfma_f32_32x32x16_bf16 v[224:239], v[60:63], v[108:111], v[224:239]
    ds_read_b64_tr_b16 v[60:61], v19 offset:40960
    ds_read_b64_tr_b16 v[62:63], v19 offset:43008
    s_waitcnt lgkmcnt(10)
    v_mfma_f32_32x32x16_bf16 v[176:191], v[40:43], v[112:115], v[176:191]
    ds_read_b64_tr_b16 v[40:41], v20 offset:40960
    ds_read_b64_tr_b16 v[42:43], v20 offset:43008
    s_waitcnt lgkmcnt(10)
    v_mfma_f32_32x32x16_bf16 v[192:207], v[44:47], v[112:115], v[192:207]
    ds_read_b64_tr_b16 v[44:45], v21 offset:40960
    ds_read_b64_tr_b16 v[46:47], v21 offset:43008
    s_waitcnt lgkmcnt(10)
    v_mfma_f32_32x32x16_bf16 v[208:223], v[48:51], v[112:115], v[208:223]
    s_barrier
    ds_read_b64_tr_b16 v[48:49], v18 offset:49152
    ds_read_b64_tr_b16 v[50:51], v18 offset:51200
    s_waitcnt lgkmcnt(10)
    v_mfma_f32_32x32x16_bf16 v[224:239], v[52:55], v[112:115], v[224:239]
    ds_read_b64_tr_b16 v[52:53], v19 offset:49152
    ds_read_b64_tr_b16 v[54:55], v19 offset:51200
    s_waitcnt lgkmcnt(10)
    v_mfma_f32_32x32x16_bf16 v[176:191], v[56:59], v[116:119], v[176:191]
    ds_read_b64_tr_b16 v[56:57], v20 offset:49152
    ds_read_b64_tr_b16 v[58:59], v20 offset:51200
    s_waitcnt lgkmcnt(10)
    v_mfma_f32_32x32x16_bf16 v[192:207], v[60:63], v[116:119], v[192:207]
    ds_read_b64_tr_b16 v[60:61], v21 offset:49152
    ds_read_b64_tr_b16 v[62:63], v21 offset:51200
    s_waitcnt lgkmcnt(10)
    v_mfma_f32_32x32x16_bf16 v[208:223], v[40:43], v[116:119], v[208:223]
    ds_read_b64_tr_b16 v[40:41], v18 offset:57344
    ds_read_b64_tr_b16 v[42:43], v18 offset:59392
    s_waitcnt lgkmcnt(10)
    v_mfma_f32_32x32x16_bf16 v[224:239], v[44:47], v[116:119], v[224:239]
    ds_read_b64_tr_b16 v[44:45], v19 offset:57344
    ds_read_b64_tr_b16 v[46:47], v19 offset:59392
    s_waitcnt lgkmcnt(10)
    v_mfma_f32_32x32x16_bf16 v[176:191], v[48:51], v[120:123], v[176:191]
    ds_read_b64_tr_b16 v[48:49], v20 offset:57344
    ds_read_b64_tr_b16 v[50:51], v20 offset:59392
    s_waitcnt lgkmcnt(10)
    v_mfma_f32_32x32x16_bf16 v[192:207], v[52:55], v[120:123], v[192:207]
    ds_read_b64_tr_b16 v[52:53], v21 offset:57344
    ds_read_b64_tr_b16 v[54:55], v21 offset:59392
    s_waitcnt lgkmcnt(10)
    v_mfma_f32_32x32x16_bf16 v[208:223], v[56:59], v[120:123], v[208:223]
    s_barrier
    s_mov_b32 s3, 65536
    v_add_u32 v18, s3, v18
    v_add_u32 v19, s3, v19
    v_add_u32 v20, s3, v20
    v_add_u32 v21, s3, v21
    ds_read_b64_tr_b16 v[56:57], v18 offset:0
    ds_read_b64_tr_b16 v[58:59], v18 offset:2048
    s_waitcnt lgkmcnt(10)
    v_mfma_f32_32x32x16_bf16 v[224:239], v[60:63], v[120:123], v[224:239]
    ds_read_b64_tr_b16 v[60:61], v19 offset:0
    ds_read_b64_tr_b16 v[62:63], v19 offset:2048
    s_waitcnt lgkmcnt(10)
    v_mfma_f32_32x32x16_bf16 v[176:191], v[40:43], v[124:127], v[176:191]
    ds_read_b64_tr_b16 v[40:41], v20 offset:0
    ds_read_b64_tr_b16 v[42:43], v20 offset:2048
    s_waitcnt lgkmcnt(10)
    v_mfma_f32_32x32x16_bf16 v[192:207], v[44:47], v[124:127], v[192:207]
    ds_read_b64_tr_b16 v[44:45], v21 offset:0
    ds_read_b64_tr_b16 v[46:47], v21 offset:2048
    s_waitcnt lgkmcnt(10)
    v_mfma_f32_32x32x16_bf16 v[208:223], v[48:51], v[124:127], v[208:223]
    ds_read_b64_tr_b16 v[48:49], v18 offset:8192
    ds_read_b64_tr_b16 v[50:51], v18 offset:10240
    s_waitcnt lgkmcnt(10)
    v_mfma_f32_32x32x16_bf16 v[224:239], v[52:55], v[124:127], v[224:239]
    ds_read_b64_tr_b16 v[52:53], v19 offset:8192
    ds_read_b64_tr_b16 v[54:55], v19 offset:10240
    s_waitcnt lgkmcnt(10)
    v_mfma_f32_32x32x16_bf16 v[176:191], v[56:59], v[128:131], v[176:191]
    ds_read_b64_tr_b16 v[56:57], v20 offset:8192
    ds_read_b64_tr_b16 v[58:59], v20 offset:10240
    s_waitcnt lgkmcnt(10)
    v_mfma_f32_32x32x16_bf16 v[192:207], v[60:63], v[128:131], v[192:207]
    ds_read_b64_tr_b16 v[60:61], v21 offset:8192
    ds_read_b64_tr_b16 v[62:63], v21 offset:10240
    s_waitcnt lgkmcnt(10)
    v_mfma_f32_32x32x16_bf16 v[208:223], v[40:43], v[128:131], v[208:223]
    s_barrier
    ds_read_b64_tr_b16 v[40:41], v18 offset:16384
    ds_read_b64_tr_b16 v[42:43], v18 offset:18432
    s_waitcnt lgkmcnt(10)
    v_mfma_f32_32x32x16_bf16 v[224:239], v[44:47], v[128:131], v[224:239]
    ds_read_b64_tr_b16 v[44:45], v19 offset:16384
    ds_read_b64_tr_b16 v[46:47], v19 offset:18432
    s_waitcnt lgkmcnt(10)
    v_mfma_f32_32x32x16_bf16 v[176:191], v[48:51], v[132:135], v[176:191]
    ds_read_b64_tr_b16 v[48:49], v20 offset:16384
    ds_read_b64_tr_b16 v[50:51], v20 offset:18432
    s_waitcnt lgkmcnt(10)
    v_mfma_f32_32x32x16_bf16 v[192:207], v[52:55], v[132:135], v[192:207]
    ds_read_b64_tr_b16 v[52:53], v21 offset:16384
    ds_read_b64_tr_b16 v[54:55], v21 offset:18432
    s_waitcnt lgkmcnt(10)
    v_mfma_f32_32x32x16_bf16 v[208:223], v[56:59], v[132:135], v[208:223]
    ds_read_b64_tr_b16 v[56:57], v18 offset:24576
    ds_read_b64_tr_b16 v[58:59], v18 offset:26624
    s_waitcnt lgkmcnt(10)
    v_mfma_f32_32x32x16_bf16 v[224:239], v[60:63], v[132:135], v[224:239]
    ds_read_b64_tr_b16 v[60:61], v19 offset:24576
    ds_read_b64_tr_b16 v[62:63], v19 offset:26624
    s_waitcnt lgkmcnt(10)
    v_mfma_f32_32x32x16_bf16 v[176:191], v[40:43], v[136:139], v[176:191]
    ds_read_b64_tr_b16 v[40:41], v20 offset:24576
    ds_read_b64_tr_b16 v[42:43], v20 offset:26624
    s_waitcnt lgkmcnt(10)
    v_mfma_f32_32x32x16_bf16 v[192:207], v[44:47], v[136:139], v[192:207]
    ds_read_b64_tr_b16 v[44:45], v21 offset:24576
    ds_read_b64_tr_b16 v[46:47], v21 offset:26624
    s_waitcnt lgkmcnt(10)
    v_mfma_f32_32x32x16_bf16 v[208:223], v[48:51], v[136:139], v[208:223]
    s_barrier
    ds_read_b64_tr_b16 v[48:49], v18 offset:32768
    ds_read_b64_tr_b16 v[50:51], v18 offset:34816
    s_waitcnt lgkmcnt(10)
    v_mfma_f32_32x32x16_bf16 v[224:239], v[52:55], v[136:139], v[224:239]
    ds_read_b64_tr_b16 v[52:53], v19 offset:32768
    ds_read_b64_tr_b16 v[54:55], v19 offset:34816
    s_waitcnt lgkmcnt(10)
    v_mfma_f32_32x32x16_bf16 v[176:191], v[56:59], v[140:143], v[176:191]
    ds_read_b64_tr_b16 v[56:57], v20 offset:32768
    ds_read_b64_tr_b16 v[58:59], v20 offset:34816
    s_waitcnt lgkmcnt(10)
    v_mfma_f32_32x32x16_bf16 v[192:207], v[60:63], v[140:143], v[192:207]
    ds_read_b64_tr_b16 v[60:61], v21 offset:32768
    ds_read_b64_tr_b16 v[62:63], v21 offset:34816
    s_waitcnt lgkmcnt(10)
    v_mfma_f32_32x32x16_bf16 v[208:223], v[40:43], v[140:143], v[208:223]
    ds_read_b64_tr_b16 v[40:41], v18 offset:40960
    ds_read_b64_tr_b16 v[42:43], v18 offset:43008
    s_waitcnt lgkmcnt(10)
    v_mfma_f32_32x32x16_bf16 v[224:239], v[44:47], v[140:143], v[224:239]
    ds_read_b64_tr_b16 v[44:45], v19 offset:40960
    ds_read_b64_tr_b16 v[46:47], v19 offset:43008
    s_waitcnt lgkmcnt(10)
    v_mfma_f32_32x32x16_bf16 v[176:191], v[48:51], v[144:147], v[176:191]
    ds_read_b64_tr_b16 v[48:49], v20 offset:40960
    ds_read_b64_tr_b16 v[50:51], v20 offset:43008
    s_waitcnt lgkmcnt(10)
    v_mfma_f32_32x32x16_bf16 v[192:207], v[52:55], v[144:147], v[192:207]
    ds_read_b64_tr_b16 v[52:53], v21 offset:40960
    ds_read_b64_tr_b16 v[54:55], v21 offset:43008
    s_waitcnt lgkmcnt(10)
    v_mfma_f32_32x32x16_bf16 v[208:223], v[56:59], v[144:147], v[208:223]
    s_barrier
    ds_read_b64_tr_b16 v[56:57], v18 offset:49152
    ds_read_b64_tr_b16 v[58:59], v18 offset:51200
    s_waitcnt lgkmcnt(10)
    v_mfma_f32_32x32x16_bf16 v[224:239], v[60:63], v[144:147], v[224:239]
    ds_read_b64_tr_b16 v[60:61], v19 offset:49152
    ds_read_b64_tr_b16 v[62:63], v19 offset:51200
    s_waitcnt lgkmcnt(10)
    v_mfma_f32_32x32x16_bf16 v[176:191], v[40:43], v[148:151], v[176:191]
    ds_read_b64_tr_b16 v[40:41], v20 offset:49152
    ds_read_b64_tr_b16 v[42:43], v20 offset:51200
    s_waitcnt lgkmcnt(10)
    v_mfma_f32_32x32x16_bf16 v[192:207], v[44:47], v[148:151], v[192:207]
    ds_read_b64_tr_b16 v[44:45], v21 offset:49152
    ds_read_b64_tr_b16 v[46:47], v21 offset:51200
    s_waitcnt lgkmcnt(10)
    v_mfma_f32_32x32x16_bf16 v[208:223], v[48:51], v[148:151], v[208:223]
    ds_read_b64_tr_b16 v[48:49], v18 offset:57344
    ds_read_b64_tr_b16 v[50:51], v18 offset:59392
    s_waitcnt lgkmcnt(10)
    v_mfma_f32_32x32x16_bf16 v[224:239], v[52:55], v[148:151], v[224:239]
    ds_read_b64_tr_b16 v[52:53], v19 offset:57344
    ds_read_b64_tr_b16 v[54:55], v19 offset:59392
    s_waitcnt lgkmcnt(10)
    v_mfma_f32_32x32x16_bf16 v[176:191], v[56:59], v[152:155], v[176:191]
    ds_read_b64_tr_b16 v[56:57], v20 offset:57344
    ds_read_b64_tr_b16 v[58:59], v20 offset:59392
    s_waitcnt lgkmcnt(10)
    v_mfma_f32_32x32x16_bf16 v[192:207], v[60:63], v[152:155], v[192:207]
    ds_read_b64_tr_b16 v[60:61], v21 offset:57344
    ds_read_b64_tr_b16 v[62:63], v21 offset:59392
    s_waitcnt lgkmcnt(10)
    v_mfma_f32_32x32x16_bf16 v[208:223], v[40:43], v[152:155], v[208:223]
    s_barrier
    s_mov_b32 s3, 4294901760
    v_add_u32 v18, s3, v18
    v_add_u32 v19, s3, v19
    v_add_u32 v20, s3, v20
    v_add_u32 v21, s3, v21
    ds_read_b64_tr_b16 v[40:41], v18 offset:0
    ds_read_b64_tr_b16 v[42:43], v18 offset:2048
    s_waitcnt lgkmcnt(10)
    v_mfma_f32_32x32x16_bf16 v[224:239], v[44:47], v[152:155], v[224:239]
    ds_read_b64_tr_b16 v[44:45], v19 offset:0
    ds_read_b64_tr_b16 v[46:47], v19 offset:2048
    s_waitcnt lgkmcnt(10)
    v_mfma_f32_32x32x16_bf16 v[176:191], v[48:51], v[156:159], v[176:191]
    ds_read_b64_tr_b16 v[48:49], v20 offset:0
    ds_read_b64_tr_b16 v[50:51], v20 offset:2048
    s_waitcnt lgkmcnt(10)
    v_mfma_f32_32x32x16_bf16 v[192:207], v[52:55], v[156:159], v[192:207]
    ds_read_b64_tr_b16 v[52:53], v21 offset:0
    ds_read_b64_tr_b16 v[54:55], v21 offset:2048
    s_waitcnt lgkmcnt(10)
    v_mfma_f32_32x32x16_bf16 v[208:223], v[56:59], v[156:159], v[208:223]
    ds_read_b64_tr_b16 v[56:57], v18 offset:8192
    ds_read_b64_tr_b16 v[58:59], v18 offset:10240
    s_waitcnt lgkmcnt(10)
    v_mfma_f32_32x32x16_bf16 v[224:239], v[60:63], v[156:159], v[224:239]
    ds_read_b64_tr_b16 v[60:61], v19 offset:8192
    ds_read_b64_tr_b16 v[62:63], v19 offset:10240
    s_waitcnt lgkmcnt(10)
    v_mfma_f32_32x32x16_bf16 v[176:191], v[40:43], v[160:163], v[176:191]
    ds_read_b64_tr_b16 v[40:41], v20 offset:8192
    ds_read_b64_tr_b16 v[42:43], v20 offset:10240
    s_waitcnt lgkmcnt(10)
    v_mfma_f32_32x32x16_bf16 v[192:207], v[44:47], v[160:163], v[192:207]
    ds_read_b64_tr_b16 v[44:45], v21 offset:8192
    ds_read_b64_tr_b16 v[46:47], v21 offset:10240
    s_waitcnt lgkmcnt(10)
    v_mfma_f32_32x32x16_bf16 v[208:223], v[48:51], v[160:163], v[208:223]
    s_barrier
    ds_read_b64_tr_b16 v[48:49], v18 offset:16384
    ds_read_b64_tr_b16 v[50:51], v18 offset:18432
    s_waitcnt lgkmcnt(10)
    v_mfma_f32_32x32x16_bf16 v[224:239], v[52:55], v[160:163], v[224:239]
    ds_read_b64_tr_b16 v[52:53], v19 offset:16384
    ds_read_b64_tr_b16 v[54:55], v19 offset:18432
    s_waitcnt lgkmcnt(10)
    v_mfma_f32_32x32x16_bf16 v[176:191], v[56:59], v[164:167], v[176:191]
    ds_read_b64_tr_b16 v[56:57], v20 offset:16384
    ds_read_b64_tr_b16 v[58:59], v20 offset:18432
    s_waitcnt lgkmcnt(10)
    v_mfma_f32_32x32x16_bf16 v[192:207], v[60:63], v[164:167], v[192:207]
    ds_read_b64_tr_b16 v[60:61], v21 offset:16384
    ds_read_b64_tr_b16 v[62:63], v21 offset:18432
    s_waitcnt lgkmcnt(10)
    v_mfma_f32_32x32x16_bf16 v[208:223], v[40:43], v[164:167], v[208:223]
    ds_read_b64_tr_b16 v[40:41], v18 offset:24576
    ds_read_b64_tr_b16 v[42:43], v18 offset:26624
    s_waitcnt lgkmcnt(10)
    v_mfma_f32_32x32x16_bf16 v[224:239], v[44:47], v[164:167], v[224:239]
    ds_read_b64_tr_b16 v[44:45], v19 offset:24576
    ds_read_b64_tr_b16 v[46:47], v19 offset:26624
    s_waitcnt lgkmcnt(10)
    v_mfma_f32_32x32x16_bf16 v[176:191], v[48:51], v[168:171], v[176:191]
    ds_read_b64_tr_b16 v[48:49], v20 offset:24576
    ds_read_b64_tr_b16 v[50:51], v20 offset:26624
    s_waitcnt lgkmcnt(10)
    v_mfma_f32_32x32x16_bf16 v[192:207], v[52:55], v[168:171], v[192:207]
    ds_read_b64_tr_b16 v[52:53], v21 offset:24576
    ds_read_b64_tr_b16 v[54:55], v21 offset:26624
    s_waitcnt lgkmcnt(10)
    v_mfma_f32_32x32x16_bf16 v[208:223], v[56:59], v[168:171], v[208:223]
    s_waitcnt lgkmcnt(8)
    v_mfma_f32_32x32x16_bf16 v[224:239], v[60:63], v[168:171], v[224:239]
    s_waitcnt lgkmcnt(6)
    v_mfma_f32_32x32x16_bf16 v[176:191], v[40:43], v[172:175], v[176:191]
    s_waitcnt lgkmcnt(4)
    v_mfma_f32_32x32x16_bf16 v[192:207], v[44:47], v[172:175], v[192:207]
    s_waitcnt lgkmcnt(2)
    v_mfma_f32_32x32x16_bf16 v[208:223], v[48:51], v[172:175], v[208:223]
    s_waitcnt lgkmcnt(0)
    v_mfma_f32_32x32x16_bf16 v[224:239], v[52:55], v[172:175], v[224:239]
    s_nop 15
    s_nop 3
    v_cvt_pk_bf16_f32 v64, v176, v177
    v_cvt_pk_bf16_f32 v65, v178, v179
    v_cvt_pk_bf16_f32 v66, v180, v181
    v_cvt_pk_bf16_f32 v67, v182, v183
    v_cvt_pk_bf16_f32 v68, v184, v185
    v_cvt_pk_bf16_f32 v69, v186, v187
    v_cvt_pk_bf16_f32 v70, v188, v189
    v_cvt_pk_bf16_f32 v71, v190, v191
    v_cvt_pk_bf16_f32 v72, v192, v193
    v_cvt_pk_bf16_f32 v73, v194, v195
    v_cvt_pk_bf16_f32 v74, v196, v197
    v_cvt_pk_bf16_f32 v75, v198, v199
    v_cvt_pk_bf16_f32 v76, v200, v201
    v_cvt_pk_bf16_f32 v77, v202, v203
    v_cvt_pk_bf16_f32 v78, v204, v205
    v_cvt_pk_bf16_f32 v79, v206, v207
    v_cvt_pk_bf16_f32 v80, v208, v209
    v_cvt_pk_bf16_f32 v81, v210, v211
    v_cvt_pk_bf16_f32 v82, v212, v213
    v_cvt_pk_bf16_f32 v83, v214, v215
    v_cvt_pk_bf16_f32 v84, v216, v217
    v_cvt_pk_bf16_f32 v85, v218, v219
    v_cvt_pk_bf16_f32 v86, v220, v221
    v_cvt_pk_bf16_f32 v87, v222, v223
    v_cvt_pk_bf16_f32 v88, v224, v225
    v_cvt_pk_bf16_f32 v89, v226, v227
    v_cvt_pk_bf16_f32 v90, v228, v229
    v_cvt_pk_bf16_f32 v91, v230, v231
    v_cvt_pk_bf16_f32 v92, v232, v233
    v_cvt_pk_bf16_f32 v93, v234, v235
    v_cvt_pk_bf16_f32 v94, v236, v237
    v_cvt_pk_bf16_f32 v95, v238, v239
    s_mov_b32 s49, 49152
    s_cmp_eq_u32 s29, 0
    s_cselect_b32 s3, 32768, s49
    s_lshl_b32 s48, s30, 13
    s_add_u32 s48, s48, s3
    v_add_u32 v32, s48, v30
    v_add_u32 v33, s3, v30
    ds_write_b128 v32, v[64:67] offset:0
    ds_write_b128 v32, v[68:71] offset:1024
    ds_write_b128 v32, v[72:75] offset:2048
    ds_write_b128 v32, v[76:79] offset:3072
    ds_write_b128 v32, v[80:83] offset:4096
    ds_write_b128 v32, v[84:87] offset:5120
    ds_write_b128 v32, v[88:91] offset:6144
    ds_write_b128 v32, v[92:95] offset:7168
    s_waitcnt lgkmcnt(0)
    s_barrier
    ds_read_b128 v[64:67], v33 offset:0
    ds_read_b128 v[68:71], v33 offset:1024
    ds_read_b128 v[72:75], v33 offset:2048
    ds_read_b128 v[76:79], v33 offset:3072
    ds_read_b128 v[80:83], v33 offset:4096
    ds_read_b128 v[84:87], v33 offset:5120
    ds_read_b128 v[88:91], v33 offset:6144
    ds_read_b128 v[92:95], v33 offset:7168
    ds_read_b128 v[96:99], v33 offset:8192
    ds_read_b128 v[100:103], v33 offset:9216
    ds_read_b128 v[104:107], v33 offset:10240
    ds_read_b128 v[108:111], v33 offset:11264
    ds_read_b128 v[112:115], v33 offset:12288
    ds_read_b128 v[116:119], v33 offset:13312
    ds_read_b128 v[120:123], v33 offset:14336
    ds_read_b128 v[124:127], v33 offset:15360
    s_waitcnt lgkmcnt(0)
    s_barrier
    s_mov_b32 s49, 147456
    s_cmp_eq_u32 s30, 0
    s_cselect_b32 s3, 131072, s49
    v_add_u32 v2, s3, v2
    v_add_u32 v3, s3, v3
    v_add_u32 v4, s3, v4
    v_add_u32 v5, s3, v5
    v_add_u32 v6, s3, v6
    v_add_u32 v7, s3, v7
    v_add_u32 v8, s3, v8
    v_add_u32 v9, s3, v9
    ds_read_b128 v[56:59], v2 offset:0
    ds_read_b128 v[60:63], v3 offset:0
    ds_read_b128 v[40:43], v4 offset:0
    ds_read_b128 v[44:47], v5 offset:0
    ds_read_b128 v[48:51], v6 offset:0
    ds_read_b128 v[52:55], v7 offset:0
    s_waitcnt lgkmcnt(5)
    v_mfma_f32_32x32x16_bf16 v[128:143], v[56:59], v[64:67], 0
    ds_read_b128 v[56:59], v8 offset:0
    s_waitcnt lgkmcnt(5)
    v_mfma_f32_32x32x16_bf16 v[128:143], v[60:63], v[68:71], v[128:143]
    ds_read_b128 v[60:63], v9 offset:0
    s_waitcnt lgkmcnt(5)
    v_mfma_f32_32x32x16_bf16 v[128:143], v[40:43], v[72:75], v[128:143]
    ds_read_b128 v[40:43], v2 offset:256
    s_waitcnt lgkmcnt(5)
    v_mfma_f32_32x32x16_bf16 v[128:143], v[44:47], v[76:79], v[128:143]
    ds_read_b128 v[44:47], v3 offset:256
    s_waitcnt lgkmcnt(5)
    v_mfma_f32_32x32x16_bf16 v[128:143], v[48:51], v[80:83], v[128:143]
    ds_read_b128 v[48:51], v4 offset:256
    s_waitcnt lgkmcnt(5)
    v_mfma_f32_32x32x16_bf16 v[128:143], v[52:55], v[84:87], v[128:143]
    ds_read_b128 v[52:55], v5 offset:256
    s_waitcnt lgkmcnt(5)
    v_mfma_f32_32x32x16_bf16 v[128:143], v[56:59], v[88:91], v[128:143]
    ds_read_b128 v[56:59], v6 offset:256
    s_waitcnt lgkmcnt(5)
    v_mfma_f32_32x32x16_bf16 v[128:143], v[60:63], v[92:95], v[128:143]
    ds_read_b128 v[60:63], v7 offset:256
    s_waitcnt lgkmcnt(5)
    v_mfma_f32_32x32x16_bf16 v[128:143], v[40:43], v[96:99], v[128:143]
    ds_read_b128 v[40:43], v8 offset:256
    s_waitcnt lgkmcnt(5)
    v_mfma_f32_32x32x16_bf16 v[128:143], v[44:47], v[100:103], v[128:143]
    ds_read_b128 v[44:47], v9 offset:256
    s_waitcnt lgkmcnt(5)
    v_mfma_f32_32x32x16_bf16 v[128:143], v[48:51], v[104:107], v[128:143]
    s_barrier
    s_mov_b32 s49, 4294901760
    s_cmp_eq_u32 s30, 0
    s_cselect_b32 s3, 4294901760, s49
    v_add_u32 v2, s3, v2
    v_add_u32 v3, s3, v3
    v_add_u32 v4, s3, v4
    v_add_u32 v5, s3, v5
    v_add_u32 v6, s3, v6
    v_add_u32 v7, s3, v7
    v_add_u32 v8, s3, v8
    v_add_u32 v9, s3, v9
    ds_read_b128 v[48:51], v2 offset:0
    s_waitcnt lgkmcnt(5)
    v_mfma_f32_32x32x16_bf16 v[128:143], v[52:55], v[108:111], v[128:143]
    ds_read_b128 v[52:55], v3 offset:0
    s_waitcnt lgkmcnt(5)
    v_mfma_f32_32x32x16_bf16 v[128:143], v[56:59], v[112:115], v[128:143]
    ds_read_b128 v[56:59], v4 offset:0
    s_waitcnt lgkmcnt(5)
    v_mfma_f32_32x32x16_bf16 v[128:143], v[60:63], v[116:119], v[128:143]
    ds_read_b128 v[60:63], v5 offset:0
    s_waitcnt lgkmcnt(5)
    v_mfma_f32_32x32x16_bf16 v[128:143], v[40:43], v[120:123], v[128:143]
    ds_read_b128 v[40:43], v6 offset:0
    s_waitcnt lgkmcnt(5)
    v_mfma_f32_32x32x16_bf16 v[128:143], v[44:47], v[124:127], v[128:143]
    ds_read_b128 v[44:47], v7 offset:0
    s_waitcnt lgkmcnt(5)
    v_mfma_f32_32x32x16_bf16 v[144:159], v[48:51], v[64:67], 0
    ds_read_b128 v[48:51], v8 offset:0
    s_waitcnt lgkmcnt(5)
    v_mfma_f32_32x32x16_bf16 v[144:159], v[52:55], v[68:71], v[144:159]
    ds_read_b128 v[52:55], v9 offset:0
    s_waitcnt lgkmcnt(5)
    v_mfma_f32_32x32x16_bf16 v[144:159], v[56:59], v[72:75], v[144:159]
    ds_read_b128 v[56:59], v2 offset:256
    s_waitcnt lgkmcnt(5)
    v_mfma_f32_32x32x16_bf16 v[144:159], v[60:63], v[76:79], v[144:159]
    ds_read_b128 v[60:63], v3 offset:256
    s_waitcnt lgkmcnt(5)
    v_mfma_f32_32x32x16_bf16 v[144:159], v[40:43], v[80:83], v[144:159]
    v_cvt_pk_bf16_f32 v32, v128, v129
    v_lshlrev_b32 v128, 16, v32
    v_and_b32 v129, 0xffff0000, v32
    v_cvt_pk_bf16_f32 v33, v130, v131
    v_lshlrev_b32 v130, 16, v33
    v_and_b32 v131, 0xffff0000, v33
    ds_read_b128 v[40:43], v4 offset:256
    s_waitcnt lgkmcnt(5)
    v_mfma_f32_32x32x16_bf16 v[144:159], v[44:47], v[84:87], v[144:159]
    v_cvt_pk_bf16_f32 v32, v132, v133
    v_lshlrev_b32 v132, 16, v32
    v_and_b32 v133, 0xffff0000, v32
    v_cvt_pk_bf16_f32 v33, v134, v135
    v_lshlrev_b32 v134, 16, v33
    v_and_b32 v135, 0xffff0000, v33
    ds_read_b128 v[44:47], v5 offset:256
    s_waitcnt lgkmcnt(5)
    v_mfma_f32_32x32x16_bf16 v[144:159], v[48:51], v[88:91], v[144:159]
    v_cvt_pk_bf16_f32 v32, v136, v137
    v_lshlrev_b32 v136, 16, v32
    v_and_b32 v137, 0xffff0000, v32
    v_cvt_pk_bf16_f32 v33, v138, v139
    v_lshlrev_b32 v138, 16, v33
    v_and_b32 v139, 0xffff0000, v33
    ds_read_b128 v[48:51], v6 offset:256
    s_waitcnt lgkmcnt(5)
    v_mfma_f32_32x32x16_bf16 v[144:159], v[52:55], v[92:95], v[144:159]
    v_cvt_pk_bf16_f32 v32, v140, v141
    v_lshlrev_b32 v140, 16, v32
    v_and_b32 v141, 0xffff0000, v32
    v_cvt_pk_bf16_f32 v33, v142, v143
    v_lshlrev_b32 v142, 16, v33
    v_and_b32 v143, 0xffff0000, v33
    ds_read_b128 v[52:55], v7 offset:256
    s_waitcnt lgkmcnt(5)
    v_mfma_f32_32x32x16_bf16 v[144:159], v[56:59], v[96:99], v[144:159]
    v_max_f32 v24, v128, v129
    v_max3_f32 v24, v24, v130, v131
    v_max3_f32 v24, v24, v132, v133
    v_max3_f32 v24, v24, v134, v135
    v_max3_f32 v24, v24, v136, v137
    v_max3_f32 v24, v24, v138, v139
    ds_read_b128 v[56:59], v8 offset:256
    s_waitcnt lgkmcnt(5)
    v_mfma_f32_32x32x16_bf16 v[144:159], v[60:63], v[100:103], v[144:159]
    v_max3_f32 v24, v24, v140, v141
    v_max3_f32 v24, v24, v142, v143
    v_mul_f32 v34, s44, v24
    v_mov_b32 v35, v34
    v_pk_fma_f32 v[128:129], v[128:129], s[42:43], v[34:35]
    v_pk_fma_f32 v[130:131], v[130:131], s[42:43], v[34:35]
    ds_read_b128 v[60:63], v9 offset:256
    s_waitcnt lgkmcnt(5)
    v_mfma_f32_32x32x16_bf16 v[144:159], v[40:43], v[104:107], v[144:159]
    v_pk_fma_f32 v[132:133], v[132:133], s[42:43], v[34:35]
    v_pk_fma_f32 v[134:135], v[134:135], s[42:43], v[34:35]
    v_pk_fma_f32 v[136:137], v[136:137], s[42:43], v[34:35]
    v_pk_fma_f32 v[138:139], v[138:139], s[42:43], v[34:35]
    v_pk_fma_f32 v[140:141], v[140:141], s[42:43], v[34:35]
    v_pk_fma_f32 v[142:143], v[142:143], s[42:43], v[34:35]
    s_barrier
    s_mov_b32 s49, 32768
    s_cmp_eq_u32 s30, 0
    s_cselect_b32 s3, 32768, s49
    v_add_u32 v2, s3, v2
    v_add_u32 v3, s3, v3
    v_add_u32 v4, s3, v4
    v_add_u32 v5, s3, v5
    v_add_u32 v6, s3, v6
    v_add_u32 v7, s3, v7
    v_add_u32 v8, s3, v8
    v_add_u32 v9, s3, v9
    ds_read_b128 v[40:43], v2 offset:0
    s_waitcnt lgkmcnt(5)
    v_mfma_f32_32x32x16_bf16 v[144:159], v[44:47], v[108:111], v[144:159]
    v_exp_f32 v128, v128
    v_exp_f32 v129, v129
    v_exp_f32 v130, v130
    v_exp_f32 v131, v131
    v_exp_f32 v132, v132
    v_exp_f32 v133, v133
    ds_read_b128 v[44:47], v3 offset:0
    s_waitcnt lgkmcnt(5)
    v_mfma_f32_32x32x16_bf16 v[144:159], v[48:51], v[112:115], v[144:159]
    v_exp_f32 v134, v134
    v_exp_f32 v135, v135
    v_exp_f32 v136, v136
    v_exp_f32 v137, v137
    v_exp_f32 v138, v138
    v_exp_f32 v139, v139
    ds_read_b128 v[48:51], v4 offset:0
    s_waitcnt lgkmcnt(5)
    v_mfma_f32_32x32x16_bf16 v[144:159], v[52:55], v[116:119], v[144:159]
    v_exp_f32 v140, v140
    v_exp_f32 v141, v141
    v_exp_f32 v142, v142
    v_exp_f32 v143, v143
    v_pk_add_f32 v[32:33], v[128:129], v[130:131]
    v_pk_add_f32 v[32:33], v[32:33], v[132:133]
    ds_read_b128 v[52:55], v5 offset:0
    s_waitcnt lgkmcnt(5)
    v_mfma_f32_32x32x16_bf16 v[144:159], v[56:59], v[120:123], v[144:159]
    v_pk_add_f32 v[32:33], v[32:33], v[134:135]
    v_pk_add_f32 v[32:33], v[32:33], v[136:137]
    v_pk_add_f32 v[32:33], v[32:33], v[138:139]
    v_pk_add_f32 v[32:33], v[32:33], v[140:141]
    v_pk_add_f32 v[32:33], v[32:33], v[142:143]
    v_add_f32 v18, v32, v33
    ds_read_b128 v[56:59], v6 offset:0
    s_waitcnt lgkmcnt(5)
    v_mfma_f32_32x32x16_bf16 v[144:159], v[60:63], v[124:127], v[144:159]
    ds_read_b128 v[60:63], v7 offset:0
    s_waitcnt lgkmcnt(5)
    v_mfma_f32_32x32x16_bf16 v[160:175], v[40:43], v[64:67], 0
    ds_read_b128 v[40:43], v8 offset:0
    s_waitcnt lgkmcnt(5)
    v_mfma_f32_32x32x16_bf16 v[160:175], v[44:47], v[68:71], v[160:175]
    ds_read_b128 v[44:47], v9 offset:0
    s_waitcnt lgkmcnt(5)
    v_mfma_f32_32x32x16_bf16 v[160:175], v[48:51], v[72:75], v[160:175]
    ds_read_b128 v[48:51], v2 offset:256
    s_waitcnt lgkmcnt(5)
    v_mfma_f32_32x32x16_bf16 v[160:175], v[52:55], v[76:79], v[160:175]
    ds_read_b128 v[52:55], v3 offset:256
    s_waitcnt lgkmcnt(5)
    v_mfma_f32_32x32x16_bf16 v[160:175], v[56:59], v[80:83], v[160:175]
    v_cvt_pk_bf16_f32 v32, v144, v145
    v_lshlrev_b32 v144, 16, v32
    v_and_b32 v145, 0xffff0000, v32
    v_cvt_pk_bf16_f32 v33, v146, v147
    v_lshlrev_b32 v146, 16, v33
    v_and_b32 v147, 0xffff0000, v33
    ds_read_b128 v[56:59], v4 offset:256
    s_waitcnt lgkmcnt(5)
    v_mfma_f32_32x32x16_bf16 v[160:175], v[60:63], v[84:87], v[160:175]
    v_cvt_pk_bf16_f32 v32, v148, v149
    v_lshlrev_b32 v148, 16, v32
    v_and_b32 v149, 0xffff0000, v32
    v_cvt_pk_bf16_f32 v33, v150, v151
    v_lshlrev_b32 v150, 16, v33
    v_and_b32 v151, 0xffff0000, v33
    ds_read_b128 v[60:63], v5 offset:256
    s_waitcnt lgkmcnt(5)
    v_mfma_f32_32x32x16_bf16 v[160:175], v[40:43], v[88:91], v[160:175]
    v_cvt_pk_bf16_f32 v32, v152, v153
    v_lshlrev_b32 v152, 16, v32
    v_and_b32 v153, 0xffff0000, v32
    v_cvt_pk_bf16_f32 v33, v154, v155
    v_lshlrev_b32 v154, 16, v33
    v_and_b32 v155, 0xffff0000, v33
    ds_read_b128 v[40:43], v6 offset:256
    s_waitcnt lgkmcnt(5)
    v_mfma_f32_32x32x16_bf16 v[160:175], v[44:47], v[92:95], v[160:175]
    v_cvt_pk_bf16_f32 v32, v156, v157
    v_lshlrev_b32 v156, 16, v32
    v_and_b32 v157, 0xffff0000, v32
    v_cvt_pk_bf16_f32 v33, v158, v159
    v_lshlrev_b32 v158, 16, v33
    v_and_b32 v159, 0xffff0000, v33
    ds_read_b128 v[44:47], v7 offset:256
    s_waitcnt lgkmcnt(5)
    v_mfma_f32_32x32x16_bf16 v[160:175], v[48:51], v[96:99], v[160:175]
    v_max_f32 v25, v144, v145
    v_max3_f32 v25, v25, v146, v147
    v_max3_f32 v25, v25, v148, v149
    v_max3_f32 v25, v25, v150, v151
    v_max3_f32 v25, v25, v152, v153
    v_max3_f32 v25, v25, v154, v155
    ds_read_b128 v[48:51], v8 offset:256
    s_waitcnt lgkmcnt(5)
    v_mfma_f32_32x32x16_bf16 v[160:175], v[52:55], v[100:103], v[160:175]
    v_max3_f32 v25, v25, v156, v157
    v_max3_f32 v25, v25, v158, v159
    v_mul_f32 v34, s44, v25
    v_mov_b32 v35, v34
    v_pk_fma_f32 v[144:145], v[144:145], s[42:43], v[34:35]
    v_pk_fma_f32 v[146:147], v[146:147], s[42:43], v[34:35]
    ds_read_b128 v[52:55], v9 offset:256
    s_waitcnt lgkmcnt(5)
    v_mfma_f32_32x32x16_bf16 v[160:175], v[56:59], v[104:107], v[160:175]
    v_pk_fma_f32 v[148:149], v[148:149], s[42:43], v[34:35]
    v_pk_fma_f32 v[150:151], v[150:151], s[42:43], v[34:35]
    v_pk_fma_f32 v[152:153], v[152:153], s[42:43], v[34:35]
    v_pk_fma_f32 v[154:155], v[154:155], s[42:43], v[34:35]
    v_pk_fma_f32 v[156:157], v[156:157], s[42:43], v[34:35]
    v_pk_fma_f32 v[158:159], v[158:159], s[42:43], v[34:35]
    s_barrier
    s_mov_b32 s49, 4294868992
    s_cmp_eq_u32 s30, 0
    s_cselect_b32 s3, 4294868992, s49
    v_add_u32 v2, s3, v2
    v_add_u32 v3, s3, v3
    v_add_u32 v4, s3, v4
    v_add_u32 v5, s3, v5
    v_add_u32 v6, s3, v6
    v_add_u32 v7, s3, v7
    v_add_u32 v8, s3, v8
    v_add_u32 v9, s3, v9
    ds_read_b128 v[56:59], v2 offset:0
    s_waitcnt lgkmcnt(5)
    v_mfma_f32_32x32x16_bf16 v[160:175], v[60:63], v[108:111], v[160:175]
    v_exp_f32 v144, v144
    v_exp_f32 v145, v145
    v_exp_f32 v146, v146
    v_exp_f32 v147, v147
    v_exp_f32 v148, v148
    v_exp_f32 v149, v149
    ds_read_b128 v[60:63], v3 offset:0
    s_waitcnt lgkmcnt(5)
    v_mfma_f32_32x32x16_bf16 v[160:175], v[40:43], v[112:115], v[160:175]
    v_exp_f32 v150, v150
    v_exp_f32 v151, v151
    v_exp_f32 v152, v152
    v_exp_f32 v153, v153
    v_exp_f32 v154, v154
    v_exp_f32 v155, v155
    ds_read_b128 v[40:43], v4 offset:0
    s_waitcnt lgkmcnt(5)
    v_mfma_f32_32x32x16_bf16 v[160:175], v[44:47], v[116:119], v[160:175]
    v_exp_f32 v156, v156
    v_exp_f32 v157, v157
    v_exp_f32 v158, v158
    v_exp_f32 v159, v159
    v_pk_add_f32 v[32:33], v[144:145], v[146:147]
    v_pk_add_f32 v[32:33], v[32:33], v[148:149]
    ds_read_b128 v[44:47], v5 offset:0
    s_waitcnt lgkmcnt(5)
    v_mfma_f32_32x32x16_bf16 v[160:175], v[48:51], v[120:123], v[160:175]
    v_pk_add_f32 v[32:33], v[32:33], v[150:151]
    v_pk_add_f32 v[32:33], v[32:33], v[152:153]
    v_pk_add_f32 v[32:33], v[32:33], v[154:155]
    v_pk_add_f32 v[32:33], v[32:33], v[156:157]
    v_pk_add_f32 v[32:33], v[32:33], v[158:159]
    v_add_f32 v19, v32, v33
    ds_read_b128 v[48:51], v6 offset:0
    s_waitcnt lgkmcnt(5)
    v_mfma_f32_32x32x16_bf16 v[160:175], v[52:55], v[124:127], v[160:175]
    ds_read_b128 v[52:55], v7 offset:0
    s_waitcnt lgkmcnt(5)
    v_mfma_f32_32x32x16_bf16 v[176:191], v[56:59], v[64:67], 0
    ds_read_b128 v[56:59], v8 offset:0
    s_waitcnt lgkmcnt(5)
    v_mfma_f32_32x32x16_bf16 v[176:191], v[60:63], v[68:71], v[176:191]
    ds_read_b128 v[60:63], v9 offset:0
    s_waitcnt lgkmcnt(5)
    v_mfma_f32_32x32x16_bf16 v[176:191], v[40:43], v[72:75], v[176:191]
    ds_read_b128 v[40:43], v2 offset:256
    s_waitcnt lgkmcnt(5)
    v_mfma_f32_32x32x16_bf16 v[176:191], v[44:47], v[76:79], v[176:191]
    ds_read_b128 v[44:47], v3 offset:256
    s_waitcnt lgkmcnt(5)
    v_mfma_f32_32x32x16_bf16 v[176:191], v[48:51], v[80:83], v[176:191]
    v_cvt_pk_bf16_f32 v32, v160, v161
    v_lshlrev_b32 v160, 16, v32
    v_and_b32 v161, 0xffff0000, v32
    v_cvt_pk_bf16_f32 v33, v162, v163
    v_lshlrev_b32 v162, 16, v33
    v_and_b32 v163, 0xffff0000, v33
    ds_read_b128 v[48:51], v4 offset:256
    s_waitcnt lgkmcnt(5)
    v_mfma_f32_32x32x16_bf16 v[176:191], v[52:55], v[84:87], v[176:191]
    v_cvt_pk_bf16_f32 v32, v164, v165
    v_lshlrev_b32 v164, 16, v32
    v_and_b32 v165, 0xffff0000, v32
    v_cvt_pk_bf16_f32 v33, v166, v167
    v_lshlrev_b32 v166, 16, v33
    v_and_b32 v167, 0xffff0000, v33
    ds_read_b128 v[52:55], v5 offset:256
    s_waitcnt lgkmcnt(5)
    v_mfma_f32_32x32x16_bf16 v[176:191], v[56:59], v[88:91], v[176:191]
    v_cvt_pk_bf16_f32 v32, v168, v169
    v_lshlrev_b32 v168, 16, v32
    v_and_b32 v169, 0xffff0000, v32
    v_cvt_pk_bf16_f32 v33, v170, v171
    v_lshlrev_b32 v170, 16, v33
    v_and_b32 v171, 0xffff0000, v33
    ds_read_b128 v[56:59], v6 offset:256
    s_waitcnt lgkmcnt(5)
    v_mfma_f32_32x32x16_bf16 v[176:191], v[60:63], v[92:95], v[176:191]
    v_cvt_pk_bf16_f32 v32, v172, v173
    v_lshlrev_b32 v172, 16, v32
    v_and_b32 v173, 0xffff0000, v32
    v_cvt_pk_bf16_f32 v33, v174, v175
    v_lshlrev_b32 v174, 16, v33
    v_and_b32 v175, 0xffff0000, v33
    ds_read_b128 v[60:63], v7 offset:256
    s_waitcnt lgkmcnt(5)
    v_mfma_f32_32x32x16_bf16 v[176:191], v[40:43], v[96:99], v[176:191]
    v_max_f32 v26, v160, v161
    v_max3_f32 v26, v26, v162, v163
    v_max3_f32 v26, v26, v164, v165
    v_max3_f32 v26, v26, v166, v167
    v_max3_f32 v26, v26, v168, v169
    v_max3_f32 v26, v26, v170, v171
    ds_read_b128 v[40:43], v8 offset:256
    s_waitcnt lgkmcnt(5)
    v_mfma_f32_32x32x16_bf16 v[176:191], v[44:47], v[100:103], v[176:191]
    v_max3_f32 v26, v26, v172, v173
    v_max3_f32 v26, v26, v174, v175
    v_mul_f32 v34, s44, v26
    v_mov_b32 v35, v34
    v_pk_fma_f32 v[160:161], v[160:161], s[42:43], v[34:35]
    v_pk_fma_f32 v[162:163], v[162:163], s[42:43], v[34:35]
    ds_read_b128 v[44:47], v9 offset:256
    s_waitcnt lgkmcnt(5)
    v_mfma_f32_32x32x16_bf16 v[176:191], v[48:51], v[104:107], v[176:191]
    v_pk_fma_f32 v[164:165], v[164:165], s[42:43], v[34:35]
    v_pk_fma_f32 v[166:167], v[166:167], s[42:43], v[34:35]
    v_pk_fma_f32 v[168:169], v[168:169], s[42:43], v[34:35]
    v_pk_fma_f32 v[170:171], v[170:171], s[42:43], v[34:35]
    v_pk_fma_f32 v[172:173], v[172:173], s[42:43], v[34:35]
    v_pk_fma_f32 v[174:175], v[174:175], s[42:43], v[34:35]
    s_barrier
    s_mov_b32 s49, 32768
    s_cmp_eq_u32 s30, 0
    s_cselect_b32 s3, 32768, s49
    v_add_u32 v2, s3, v2
    v_add_u32 v3, s3, v3
    v_add_u32 v4, s3, v4
    v_add_u32 v5, s3, v5
    v_add_u32 v6, s3, v6
    v_add_u32 v7, s3, v7
    v_add_u32 v8, s3, v8
    v_add_u32 v9, s3, v9
    ds_read_b128 v[48:51], v2 offset:0
    s_waitcnt lgkmcnt(5)
    v_mfma_f32_32x32x16_bf16 v[176:191], v[52:55], v[108:111], v[176:191]
    v_exp_f32 v160, v160
    v_exp_f32 v161, v161
    v_exp_f32 v162, v162
    v_exp_f32 v163, v163
    v_exp_f32 v164, v164
    v_exp_f32 v165, v165
    ds_read_b128 v[52:55], v3 offset:0
    s_waitcnt lgkmcnt(5)
    v_mfma_f32_32x32x16_bf16 v[176:191], v[56:59], v[112:115], v[176:191]
    v_exp_f32 v166, v166
    v_exp_f32 v167, v167
    v_exp_f32 v168, v168
    v_exp_f32 v169, v169
    v_exp_f32 v170, v170
    v_exp_f32 v171, v171
    ds_read_b128 v[56:59], v4 offset:0
    s_waitcnt lgkmcnt(5)
    v_mfma_f32_32x32x16_bf16 v[176:191], v[60:63], v[116:119], v[176:191]
    v_exp_f32 v172, v172
    v_exp_f32 v173, v173
    v_exp_f32 v174, v174
    v_exp_f32 v175, v175
    v_pk_add_f32 v[32:33], v[160:161], v[162:163]
    v_pk_add_f32 v[32:33], v[32:33], v[164:165]
    ds_read_b128 v[60:63], v5 offset:0
    s_waitcnt lgkmcnt(5)
    v_mfma_f32_32x32x16_bf16 v[176:191], v[40:43], v[120:123], v[176:191]
    v_pk_add_f32 v[32:33], v[32:33], v[166:167]
    v_pk_add_f32 v[32:33], v[32:33], v[168:169]
    v_pk_add_f32 v[32:33], v[32:33], v[170:171]
    v_pk_add_f32 v[32:33], v[32:33], v[172:173]
    v_pk_add_f32 v[32:33], v[32:33], v[174:175]
    v_add_f32 v20, v32, v33
    ds_read_b128 v[40:43], v6 offset:0
    s_waitcnt lgkmcnt(5)
    v_mfma_f32_32x32x16_bf16 v[176:191], v[44:47], v[124:127], v[176:191]
    ds_read_b128 v[44:47], v7 offset:0
    s_waitcnt lgkmcnt(5)
    v_mfma_f32_32x32x16_bf16 v[192:207], v[48:51], v[64:67], 0
    ds_read_b128 v[48:51], v8 offset:0
    s_waitcnt lgkmcnt(5)
    v_mfma_f32_32x32x16_bf16 v[192:207], v[52:55], v[68:71], v[192:207]
    ds_read_b128 v[52:55], v9 offset:0
    s_waitcnt lgkmcnt(5)
    v_mfma_f32_32x32x16_bf16 v[192:207], v[56:59], v[72:75], v[192:207]
    ds_read_b128 v[56:59], v2 offset:256
    s_waitcnt lgkmcnt(5)
    v_mfma_f32_32x32x16_bf16 v[192:207], v[60:63], v[76:79], v[192:207]
    ds_read_b128 v[60:63], v3 offset:256
    s_waitcnt lgkmcnt(5)
    v_mfma_f32_32x32x16_bf16 v[192:207], v[40:43], v[80:83], v[192:207]
    v_cvt_pk_bf16_f32 v32, v176, v177
    v_lshlrev_b32 v176, 16, v32
    v_and_b32 v177, 0xffff0000, v32
    v_cvt_pk_bf16_f32 v33, v178, v179
    v_lshlrev_b32 v178, 16, v33
    v_and_b32 v179, 0xffff0000, v33
    ds_read_b128 v[40:43], v4 offset:256
    s_waitcnt lgkmcnt(5)
    v_mfma_f32_32x32x16_bf16 v[192:207], v[44:47], v[84:87], v[192:207]
    v_cvt_pk_bf16_f32 v32, v180, v181
    v_lshlrev_b32 v180, 16, v32
    v_and_b32 v181, 0xffff0000, v32
    v_cvt_pk_bf16_f32 v33, v182, v183
    v_lshlrev_b32 v182, 16, v33
    v_and_b32 v183, 0xffff0000, v33
    ds_read_b128 v[44:47], v5 offset:256
    s_waitcnt lgkmcnt(5)
    v_mfma_f32_32x32x16_bf16 v[192:207], v[48:51], v[88:91], v[192:207]
    v_cvt_pk_bf16_f32 v32, v184, v185
    v_lshlrev_b32 v184, 16, v32
    v_and_b32 v185, 0xffff0000, v32
    v_cvt_pk_bf16_f32 v33, v186, v187
    v_lshlrev_b32 v186, 16, v33
    v_and_b32 v187, 0xffff0000, v33
    ds_read_b128 v[48:51], v6 offset:256
    s_waitcnt lgkmcnt(5)
    v_mfma_f32_32x32x16_bf16 v[192:207], v[52:55], v[92:95], v[192:207]
    v_cvt_pk_bf16_f32 v32, v188, v189
    v_lshlrev_b32 v188, 16, v32
    v_and_b32 v189, 0xffff0000, v32
    v_cvt_pk_bf16_f32 v33, v190, v191
    v_lshlrev_b32 v190, 16, v33
    v_and_b32 v191, 0xffff0000, v33
    ds_read_b128 v[52:55], v7 offset:256
    s_waitcnt lgkmcnt(5)
    v_mfma_f32_32x32x16_bf16 v[192:207], v[56:59], v[96:99], v[192:207]
    v_max_f32 v27, v176, v177
    v_max3_f32 v27, v27, v178, v179
    v_max3_f32 v27, v27, v180, v181
    v_max3_f32 v27, v27, v182, v183
    v_max3_f32 v27, v27, v184, v185
    v_max3_f32 v27, v27, v186, v187
    ds_read_b128 v[56:59], v8 offset:256
    s_waitcnt lgkmcnt(5)
    v_mfma_f32_32x32x16_bf16 v[192:207], v[60:63], v[100:103], v[192:207]
    v_max3_f32 v27, v27, v188, v189
    v_max3_f32 v27, v27, v190, v191
    v_mul_f32 v34, s44, v27
    v_mov_b32 v35, v34
    v_pk_fma_f32 v[176:177], v[176:177], s[42:43], v[34:35]
    v_pk_fma_f32 v[178:179], v[178:179], s[42:43], v[34:35]
    ds_read_b128 v[60:63], v9 offset:256
    s_waitcnt lgkmcnt(5)
    v_mfma_f32_32x32x16_bf16 v[192:207], v[40:43], v[104:107], v[192:207]
    v_pk_fma_f32 v[180:181], v[180:181], s[42:43], v[34:35]
    v_pk_fma_f32 v[182:183], v[182:183], s[42:43], v[34:35]
    v_pk_fma_f32 v[184:185], v[184:185], s[42:43], v[34:35]
    v_pk_fma_f32 v[186:187], v[186:187], s[42:43], v[34:35]
    v_pk_fma_f32 v[188:189], v[188:189], s[42:43], v[34:35]
    v_pk_fma_f32 v[190:191], v[190:191], s[42:43], v[34:35]
    s_barrier
    s_mov_b32 s49, 98304
    s_cmp_eq_u32 s30, 0
    s_cselect_b32 s3, 98304, s49
    v_add_u32 v2, s3, v2
    v_add_u32 v3, s3, v3
    v_add_u32 v4, s3, v4
    v_add_u32 v5, s3, v5
    v_add_u32 v6, s3, v6
    v_add_u32 v7, s3, v7
    v_add_u32 v8, s3, v8
    v_add_u32 v9, s3, v9
    ds_read_b128 v[40:43], v2 offset:0
    s_waitcnt lgkmcnt(5)
    v_mfma_f32_32x32x16_bf16 v[192:207], v[44:47], v[108:111], v[192:207]
    v_exp_f32 v176, v176
    v_exp_f32 v177, v177
    v_exp_f32 v178, v178
    v_exp_f32 v179, v179
    v_exp_f32 v180, v180
    v_exp_f32 v181, v181
    ds_read_b128 v[44:47], v3 offset:0
    s_waitcnt lgkmcnt(5)
    v_mfma_f32_32x32x16_bf16 v[192:207], v[48:51], v[112:115], v[192:207]
    v_exp_f32 v182, v182
    v_exp_f32 v183, v183
    v_exp_f32 v184, v184
    v_exp_f32 v185, v185
    v_exp_f32 v186, v186
    v_exp_f32 v187, v187
    ds_read_b128 v[48:51], v4 offset:0
    s_waitcnt lgkmcnt(5)
    v_mfma_f32_32x32x16_bf16 v[192:207], v[52:55], v[116:119], v[192:207]
    v_exp_f32 v188, v188
    v_exp_f32 v189, v189
    v_exp_f32 v190, v190
    v_exp_f32 v191, v191
    v_pk_add_f32 v[32:33], v[176:177], v[178:179]
    v_pk_add_f32 v[32:33], v[32:33], v[180:181]
    ds_read_b128 v[52:55], v5 offset:0
    s_waitcnt lgkmcnt(5)
    v_mfma_f32_32x32x16_bf16 v[192:207], v[56:59], v[120:123], v[192:207]
    v_pk_add_f32 v[32:33], v[32:33], v[182:183]
    v_pk_add_f32 v[32:33], v[32:33], v[184:185]
    v_pk_add_f32 v[32:33], v[32:33], v[186:187]
    v_pk_add_f32 v[32:33], v[32:33], v[188:189]
    v_pk_add_f32 v[32:33], v[32:33], v[190:191]
    v_add_f32 v21, v32, v33
    ds_read_b128 v[56:59], v6 offset:0
    s_waitcnt lgkmcnt(5)
    v_mfma_f32_32x32x16_bf16 v[192:207], v[60:63], v[124:127], v[192:207]
    ds_read_b128 v[60:63], v7 offset:0
    s_waitcnt lgkmcnt(5)
    v_mfma_f32_32x32x16_bf16 v[208:223], v[40:43], v[64:67], 0
    ds_read_b128 v[40:43], v8 offset:0
    s_waitcnt lgkmcnt(5)
    v_mfma_f32_32x32x16_bf16 v[208:223], v[44:47], v[68:71], v[208:223]
    ds_read_b128 v[44:47], v9 offset:0
    s_waitcnt lgkmcnt(5)
    v_mfma_f32_32x32x16_bf16 v[208:223], v[48:51], v[72:75], v[208:223]
    ds_read_b128 v[48:51], v2 offset:256
    s_waitcnt lgkmcnt(5)
    v_mfma_f32_32x32x16_bf16 v[208:223], v[52:55], v[76:79], v[208:223]
    ds_read_b128 v[52:55], v3 offset:256
    s_waitcnt lgkmcnt(5)
    v_mfma_f32_32x32x16_bf16 v[208:223], v[56:59], v[80:83], v[208:223]
    v_cvt_pk_bf16_f32 v32, v192, v193
    v_lshlrev_b32 v192, 16, v32
    v_and_b32 v193, 0xffff0000, v32
    v_cvt_pk_bf16_f32 v33, v194, v195
    v_lshlrev_b32 v194, 16, v33
    v_and_b32 v195, 0xffff0000, v33
    ds_read_b128 v[56:59], v4 offset:256
    s_waitcnt lgkmcnt(5)
    v_mfma_f32_32x32x16_bf16 v[208:223], v[60:63], v[84:87], v[208:223]
    v_cvt_pk_bf16_f32 v32, v196, v197
    v_lshlrev_b32 v196, 16, v32
    v_and_b32 v197, 0xffff0000, v32
    v_cvt_pk_bf16_f32 v33, v198, v199
    v_lshlrev_b32 v198, 16, v33
    v_and_b32 v199, 0xffff0000, v33
    ds_read_b128 v[60:63], v5 offset:256
    s_waitcnt lgkmcnt(5)
    v_mfma_f32_32x32x16_bf16 v[208:223], v[40:43], v[88:91], v[208:223]
    v_cvt_pk_bf16_f32 v32, v200, v201
    v_lshlrev_b32 v200, 16, v32
    v_and_b32 v201, 0xffff0000, v32
    v_cvt_pk_bf16_f32 v33, v202, v203
    v_lshlrev_b32 v202, 16, v33
    v_and_b32 v203, 0xffff0000, v33
    ds_read_b128 v[40:43], v6 offset:256
    s_waitcnt lgkmcnt(5)
    v_mfma_f32_32x32x16_bf16 v[208:223], v[44:47], v[92:95], v[208:223]
    v_cvt_pk_bf16_f32 v32, v204, v205
    v_lshlrev_b32 v204, 16, v32
    v_and_b32 v205, 0xffff0000, v32
    v_cvt_pk_bf16_f32 v33, v206, v207
    v_lshlrev_b32 v206, 16, v33
    v_and_b32 v207, 0xffff0000, v33
    ds_read_b128 v[44:47], v7 offset:256
    s_waitcnt lgkmcnt(5)
    v_mfma_f32_32x32x16_bf16 v[208:223], v[48:51], v[96:99], v[208:223]
    v_max_f32 v28, v192, v193
    v_max3_f32 v28, v28, v194, v195
    v_max3_f32 v28, v28, v196, v197
    v_max3_f32 v28, v28, v198, v199
    v_max3_f32 v28, v28, v200, v201
    v_max3_f32 v28, v28, v202, v203
    ds_read_b128 v[48:51], v8 offset:256
    s_waitcnt lgkmcnt(5)
    v_mfma_f32_32x32x16_bf16 v[208:223], v[52:55], v[100:103], v[208:223]
    v_max3_f32 v28, v28, v204, v205
    v_max3_f32 v28, v28, v206, v207
    v_mul_f32 v34, s44, v28
    v_mov_b32 v35, v34
    v_pk_fma_f32 v[192:193], v[192:193], s[42:43], v[34:35]
    v_pk_fma_f32 v[194:195], v[194:195], s[42:43], v[34:35]
    ds_read_b128 v[52:55], v9 offset:256
    s_waitcnt lgkmcnt(5)
    v_mfma_f32_32x32x16_bf16 v[208:223], v[56:59], v[104:107], v[208:223]
    v_pk_fma_f32 v[196:197], v[196:197], s[42:43], v[34:35]
    v_pk_fma_f32 v[198:199], v[198:199], s[42:43], v[34:35]
    v_pk_fma_f32 v[200:201], v[200:201], s[42:43], v[34:35]
    v_pk_fma_f32 v[202:203], v[202:203], s[42:43], v[34:35]
    v_pk_fma_f32 v[204:205], v[204:205], s[42:43], v[34:35]
    v_pk_fma_f32 v[206:207], v[206:207], s[42:43], v[34:35]
    s_barrier
    s_mov_b32 s49, 4294901760
    s_cmp_eq_u32 s30, 0
    s_cselect_b32 s3, 4294901760, s49
    v_add_u32 v2, s3, v2
    v_add_u32 v3, s3, v3
    v_add_u32 v4, s3, v4
    v_add_u32 v5, s3, v5
    v_add_u32 v6, s3, v6
    v_add_u32 v7, s3, v7
    v_add_u32 v8, s3, v8
    v_add_u32 v9, s3, v9
    ds_read_b128 v[56:59], v2 offset:0
    s_waitcnt lgkmcnt(5)
    v_mfma_f32_32x32x16_bf16 v[208:223], v[60:63], v[108:111], v[208:223]
    v_exp_f32 v192, v192
    v_exp_f32 v193, v193
    v_exp_f32 v194, v194
    v_exp_f32 v195, v195
    v_exp_f32 v196, v196
    v_exp_f32 v197, v197
    ds_read_b128 v[60:63], v3 offset:0
    s_waitcnt lgkmcnt(5)
    v_mfma_f32_32x32x16_bf16 v[208:223], v[40:43], v[112:115], v[208:223]
    v_exp_f32 v198, v198
    v_exp_f32 v199, v199
    v_exp_f32 v200, v200
    v_exp_f32 v201, v201
    v_exp_f32 v202, v202
    v_exp_f32 v203, v203
    ds_read_b128 v[40:43], v4 offset:0
    s_waitcnt lgkmcnt(5)
    v_mfma_f32_32x32x16_bf16 v[208:223], v[44:47], v[116:119], v[208:223]
    v_exp_f32 v204, v204
    v_exp_f32 v205, v205
    v_exp_f32 v206, v206
    v_exp_f32 v207, v207
    v_pk_add_f32 v[32:33], v[192:193], v[194:195]
    v_pk_add_f32 v[32:33], v[32:33], v[196:197]
    ds_read_b128 v[44:47], v5 offset:0
    s_waitcnt lgkmcnt(5)
    v_mfma_f32_32x32x16_bf16 v[208:223], v[48:51], v[120:123], v[208:223]
    v_pk_add_f32 v[32:33], v[32:33], v[198:199]
    v_pk_add_f32 v[32:33], v[32:33], v[200:201]
    v_pk_add_f32 v[32:33], v[32:33], v[202:203]
    v_pk_add_f32 v[32:33], v[32:33], v[204:205]
    v_pk_add_f32 v[32:33], v[32:33], v[206:207]
    v_add_f32 v0, v32, v33
    ds_read_b128 v[48:51], v6 offset:0
    s_waitcnt lgkmcnt(5)
    v_mfma_f32_32x32x16_bf16 v[208:223], v[52:55], v[124:127], v[208:223]
    ds_read_b128 v[52:55], v7 offset:0
    s_waitcnt lgkmcnt(5)
    v_mfma_f32_32x32x16_bf16 v[224:239], v[56:59], v[64:67], 0
    ds_read_b128 v[56:59], v8 offset:0
    s_waitcnt lgkmcnt(5)
    v_mfma_f32_32x32x16_bf16 v[224:239], v[60:63], v[68:71], v[224:239]
    ds_read_b128 v[60:63], v9 offset:0
    s_waitcnt lgkmcnt(5)
    v_mfma_f32_32x32x16_bf16 v[224:239], v[40:43], v[72:75], v[224:239]
    ds_read_b128 v[40:43], v2 offset:256
    s_waitcnt lgkmcnt(5)
    v_mfma_f32_32x32x16_bf16 v[224:239], v[44:47], v[76:79], v[224:239]
    ds_read_b128 v[44:47], v3 offset:256
    s_waitcnt lgkmcnt(5)
    v_mfma_f32_32x32x16_bf16 v[224:239], v[48:51], v[80:83], v[224:239]
    v_cvt_pk_bf16_f32 v32, v208, v209
    v_lshlrev_b32 v208, 16, v32
    v_and_b32 v209, 0xffff0000, v32
    v_cvt_pk_bf16_f32 v33, v210, v211
    v_lshlrev_b32 v210, 16, v33
    v_and_b32 v211, 0xffff0000, v33
    ds_read_b128 v[48:51], v4 offset:256
    s_waitcnt lgkmcnt(5)
    v_mfma_f32_32x32x16_bf16 v[224:239], v[52:55], v[84:87], v[224:239]
    v_cvt_pk_bf16_f32 v32, v212, v213
    v_lshlrev_b32 v212, 16, v32
    v_and_b32 v213, 0xffff0000, v32
    v_cvt_pk_bf16_f32 v33, v214, v215
    v_lshlrev_b32 v214, 16, v33
    v_and_b32 v215, 0xffff0000, v33
    ds_read_b128 v[52:55], v5 offset:256
    s_waitcnt lgkmcnt(5)
    v_mfma_f32_32x32x16_bf16 v[224:239], v[56:59], v[88:91], v[224:239]
    v_cvt_pk_bf16_f32 v32, v216, v217
    v_lshlrev_b32 v216, 16, v32
    v_and_b32 v217, 0xffff0000, v32
    v_cvt_pk_bf16_f32 v33, v218, v219
    v_lshlrev_b32 v218, 16, v33
    v_and_b32 v219, 0xffff0000, v33
    ds_read_b128 v[56:59], v6 offset:256
    s_waitcnt lgkmcnt(5)
    v_mfma_f32_32x32x16_bf16 v[224:239], v[60:63], v[92:95], v[224:239]
    v_cvt_pk_bf16_f32 v32, v220, v221
    v_lshlrev_b32 v220, 16, v32
    v_and_b32 v221, 0xffff0000, v32
    v_cvt_pk_bf16_f32 v33, v222, v223
    v_lshlrev_b32 v222, 16, v33
    v_and_b32 v223, 0xffff0000, v33
    ds_read_b128 v[60:63], v7 offset:256
    s_waitcnt lgkmcnt(5)
    v_mfma_f32_32x32x16_bf16 v[224:239], v[40:43], v[96:99], v[224:239]
    v_max_f32 v29, v208, v209
    v_max3_f32 v29, v29, v210, v211
    v_max3_f32 v29, v29, v212, v213
    v_max3_f32 v29, v29, v214, v215
    v_max3_f32 v29, v29, v216, v217
    v_max3_f32 v29, v29, v218, v219
    ds_read_b128 v[40:43], v8 offset:256
    s_waitcnt lgkmcnt(5)
    v_mfma_f32_32x32x16_bf16 v[224:239], v[44:47], v[100:103], v[224:239]
    v_max3_f32 v29, v29, v220, v221
    v_max3_f32 v29, v29, v222, v223
    v_mul_f32 v34, s44, v29
    v_mov_b32 v35, v34
    v_pk_fma_f32 v[208:209], v[208:209], s[42:43], v[34:35]
    v_pk_fma_f32 v[210:211], v[210:211], s[42:43], v[34:35]
    ds_read_b128 v[44:47], v9 offset:256
    s_waitcnt lgkmcnt(5)
    v_mfma_f32_32x32x16_bf16 v[224:239], v[48:51], v[104:107], v[224:239]
    v_pk_fma_f32 v[212:213], v[212:213], s[42:43], v[34:35]
    v_pk_fma_f32 v[214:215], v[214:215], s[42:43], v[34:35]
    v_pk_fma_f32 v[216:217], v[216:217], s[42:43], v[34:35]
    v_pk_fma_f32 v[218:219], v[218:219], s[42:43], v[34:35]
    v_pk_fma_f32 v[220:221], v[220:221], s[42:43], v[34:35]
    v_pk_fma_f32 v[222:223], v[222:223], s[42:43], v[34:35]
    s_barrier
    s_mov_b32 s49, 32768
    s_cmp_eq_u32 s30, 0
    s_cselect_b32 s3, 32768, s49
    v_add_u32 v2, s3, v2
    v_add_u32 v3, s3, v3
    v_add_u32 v4, s3, v4
    v_add_u32 v5, s3, v5
    v_add_u32 v6, s3, v6
    v_add_u32 v7, s3, v7
    v_add_u32 v8, s3, v8
    v_add_u32 v9, s3, v9
    ds_read_b128 v[48:51], v2 offset:0
    s_waitcnt lgkmcnt(5)
    v_mfma_f32_32x32x16_bf16 v[224:239], v[52:55], v[108:111], v[224:239]
    v_exp_f32 v208, v208
    v_exp_f32 v209, v209
    v_exp_f32 v210, v210
    v_exp_f32 v211, v211
    v_exp_f32 v212, v212
    v_exp_f32 v213, v213
    ds_read_b128 v[52:55], v3 offset:0
    s_waitcnt lgkmcnt(5)
    v_mfma_f32_32x32x16_bf16 v[224:239], v[56:59], v[112:115], v[224:239]
    v_exp_f32 v214, v214
    v_exp_f32 v215, v215
    v_exp_f32 v216, v216
    v_exp_f32 v217, v217
    v_exp_f32 v218, v218
    v_exp_f32 v219, v219
    ds_read_b128 v[56:59], v4 offset:0
    s_waitcnt lgkmcnt(5)
    v_mfma_f32_32x32x16_bf16 v[224:239], v[60:63], v[116:119], v[224:239]
    v_exp_f32 v220, v220
    v_exp_f32 v221, v221
    v_exp_f32 v222, v222
    v_exp_f32 v223, v223
    v_pk_add_f32 v[32:33], v[208:209], v[210:211]
    v_pk_add_f32 v[32:33], v[32:33], v[212:213]
    ds_read_b128 v[60:63], v5 offset:0
    s_waitcnt lgkmcnt(5)
    v_mfma_f32_32x32x16_bf16 v[224:239], v[40:43], v[120:123], v[224:239]
    v_pk_add_f32 v[32:33], v[32:33], v[214:215]
    v_pk_add_f32 v[32:33], v[32:33], v[216:217]
    v_pk_add_f32 v[32:33], v[32:33], v[218:219]
    v_pk_add_f32 v[32:33], v[32:33], v[220:221]
    v_pk_add_f32 v[32:33], v[32:33], v[222:223]
    v_add_f32 v38, v32, v33
    ds_read_b128 v[40:43], v6 offset:0
    s_waitcnt lgkmcnt(5)
    v_mfma_f32_32x32x16_bf16 v[224:239], v[44:47], v[124:127], v[224:239]
    ds_read_b128 v[44:47], v7 offset:0
    s_waitcnt lgkmcnt(5)
    v_mfma_f32_32x32x16_bf16 v[240:255], v[48:51], v[64:67], 0
    ds_read_b128 v[48:51], v8 offset:0
    s_waitcnt lgkmcnt(5)
    v_mfma_f32_32x32x16_bf16 v[240:255], v[52:55], v[68:71], v[240:255]
    ds_read_b128 v[52:55], v9 offset:0
    s_waitcnt lgkmcnt(5)
    v_mfma_f32_32x32x16_bf16 v[240:255], v[56:59], v[72:75], v[240:255]
    ds_read_b128 v[56:59], v2 offset:256
    s_waitcnt lgkmcnt(5)
    v_mfma_f32_32x32x16_bf16 v[240:255], v[60:63], v[76:79], v[240:255]
    ds_read_b128 v[60:63], v3 offset:256
    s_waitcnt lgkmcnt(5)
    v_mfma_f32_32x32x16_bf16 v[240:255], v[40:43], v[80:83], v[240:255]
    v_cvt_pk_bf16_f32 v32, v224, v225
    v_lshlrev_b32 v224, 16, v32
    v_and_b32 v225, 0xffff0000, v32
    v_cvt_pk_bf16_f32 v33, v226, v227
    v_lshlrev_b32 v226, 16, v33
    v_and_b32 v227, 0xffff0000, v33
    ds_read_b128 v[40:43], v4 offset:256
    s_waitcnt lgkmcnt(5)
    v_mfma_f32_32x32x16_bf16 v[240:255], v[44:47], v[84:87], v[240:255]
    v_cvt_pk_bf16_f32 v32, v228, v229
    v_lshlrev_b32 v228, 16, v32
    v_and_b32 v229, 0xffff0000, v32
    v_cvt_pk_bf16_f32 v33, v230, v231
    v_lshlrev_b32 v230, 16, v33
    v_and_b32 v231, 0xffff0000, v33
    ds_read_b128 v[44:47], v5 offset:256
    s_waitcnt lgkmcnt(5)
    v_mfma_f32_32x32x16_bf16 v[240:255], v[48:51], v[88:91], v[240:255]
    v_cvt_pk_bf16_f32 v32, v232, v233
    v_lshlrev_b32 v232, 16, v32
    v_and_b32 v233, 0xffff0000, v32
    v_cvt_pk_bf16_f32 v33, v234, v235
    v_lshlrev_b32 v234, 16, v33
    v_and_b32 v235, 0xffff0000, v33
    ds_read_b128 v[48:51], v6 offset:256
    s_waitcnt lgkmcnt(5)
    v_mfma_f32_32x32x16_bf16 v[240:255], v[52:55], v[92:95], v[240:255]
    v_cvt_pk_bf16_f32 v32, v236, v237
    v_lshlrev_b32 v236, 16, v32
    v_and_b32 v237, 0xffff0000, v32
    v_cvt_pk_bf16_f32 v33, v238, v239
    v_lshlrev_b32 v238, 16, v33
    v_and_b32 v239, 0xffff0000, v33
    ds_read_b128 v[52:55], v7 offset:256
    s_waitcnt lgkmcnt(5)
    v_mfma_f32_32x32x16_bf16 v[240:255], v[56:59], v[96:99], v[240:255]
    v_max_f32 v31, v224, v225
    v_max3_f32 v31, v31, v226, v227
    v_max3_f32 v31, v31, v228, v229
    v_max3_f32 v31, v31, v230, v231
    v_max3_f32 v31, v31, v232, v233
    v_max3_f32 v31, v31, v234, v235
    ds_read_b128 v[56:59], v8 offset:256
    s_waitcnt lgkmcnt(5)
    v_mfma_f32_32x32x16_bf16 v[240:255], v[60:63], v[100:103], v[240:255]
    v_max3_f32 v31, v31, v236, v237
    v_max3_f32 v31, v31, v238, v239
    v_mul_f32 v34, s44, v31
    v_mov_b32 v35, v34
    v_pk_fma_f32 v[224:225], v[224:225], s[42:43], v[34:35]
    v_pk_fma_f32 v[226:227], v[226:227], s[42:43], v[34:35]
    ds_read_b128 v[60:63], v9 offset:256
    s_waitcnt lgkmcnt(5)
    v_mfma_f32_32x32x16_bf16 v[240:255], v[40:43], v[104:107], v[240:255]
    v_pk_fma_f32 v[228:229], v[228:229], s[42:43], v[34:35]
    v_pk_fma_f32 v[230:231], v[230:231], s[42:43], v[34:35]
    v_pk_fma_f32 v[232:233], v[232:233], s[42:43], v[34:35]
    v_pk_fma_f32 v[234:235], v[234:235], s[42:43], v[34:35]
    v_pk_fma_f32 v[236:237], v[236:237], s[42:43], v[34:35]
    v_pk_fma_f32 v[238:239], v[238:239], s[42:43], v[34:35]
    s_waitcnt lgkmcnt(4)
    v_mfma_f32_32x32x16_bf16 v[240:255], v[44:47], v[108:111], v[240:255]
    v_exp_f32 v224, v224
    v_exp_f32 v225, v225
    v_exp_f32 v226, v226
    v_exp_f32 v227, v227
    v_exp_f32 v228, v228
    v_exp_f32 v229, v229
    s_waitcnt lgkmcnt(3)
    v_mfma_f32_32x32x16_bf16 v[240:255], v[48:51], v[112:115], v[240:255]
    v_exp_f32 v230, v230
    v_exp_f32 v231, v231
    v_exp_f32 v232, v232
    v_exp_f32 v233, v233
    v_exp_f32 v234, v234
    v_exp_f32 v235, v235
    s_waitcnt lgkmcnt(2)
    v_mfma_f32_32x32x16_bf16 v[240:255], v[52:55], v[116:119], v[240:255]
    v_exp_f32 v236, v236
    v_exp_f32 v237, v237
    v_exp_f32 v238, v238
    v_exp_f32 v239, v239
    v_pk_add_f32 v[32:33], v[224:225], v[226:227]
    v_pk_add_f32 v[32:33], v[32:33], v[228:229]
    s_waitcnt lgkmcnt(1)
    v_mfma_f32_32x32x16_bf16 v[240:255], v[56:59], v[120:123], v[240:255]
    v_pk_add_f32 v[32:33], v[32:33], v[230:231]
    v_pk_add_f32 v[32:33], v[32:33], v[232:233]
    v_pk_add_f32 v[32:33], v[32:33], v[234:235]
    v_pk_add_f32 v[32:33], v[32:33], v[236:237]
    v_pk_add_f32 v[32:33], v[32:33], v[238:239]
    v_add_f32 v39, v32, v33
    s_waitcnt lgkmcnt(0)
    v_mfma_f32_32x32x16_bf16 v[240:255], v[60:63], v[124:127], v[240:255]
    s_barrier
    s_nop 15
    v_cvt_pk_bf16_f32 v32, v240, v241
    v_lshlrev_b32 v240, 16, v32
    v_and_b32 v241, 0xffff0000, v32
    v_cvt_pk_bf16_f32 v33, v242, v243
    v_lshlrev_b32 v242, 16, v33
    v_and_b32 v243, 0xffff0000, v33
    v_cvt_pk_bf16_f32 v32, v244, v245
    v_lshlrev_b32 v244, 16, v32
    v_and_b32 v245, 0xffff0000, v32
    v_cvt_pk_bf16_f32 v33, v246, v247
    v_lshlrev_b32 v246, 16, v33
    v_and_b32 v247, 0xffff0000, v33
    v_cvt_pk_bf16_f32 v32, v248, v249
    v_lshlrev_b32 v248, 16, v32
    v_and_b32 v249, 0xffff0000, v32
    v_cvt_pk_bf16_f32 v33, v250, v251
    v_lshlrev_b32 v250, 16, v33
    v_and_b32 v251, 0xffff0000, v33
    v_cvt_pk_bf16_f32 v32, v252, v253
    v_lshlrev_b32 v252, 16, v32
    v_and_b32 v253, 0xffff0000, v32
    v_cvt_pk_bf16_f32 v33, v254, v255
    v_lshlrev_b32 v254, 16, v33
    v_and_b32 v255, 0xffff0000, v33
    v_max_f32 v23, v240, v241
    v_max3_f32 v23, v23, v242, v243
    v_max3_f32 v23, v23, v244, v245
    v_max3_f32 v23, v23, v246, v247
    v_max3_f32 v23, v23, v248, v249
    v_max3_f32 v23, v23, v250, v251
    v_max3_f32 v23, v23, v252, v253
    v_max3_f32 v23, v23, v254, v255
    v_mul_f32 v34, s44, v23
    v_mov_b32 v35, v34
    v_pk_fma_f32 v[240:241], v[240:241], s[42:43], v[34:35]
    v_pk_fma_f32 v[242:243], v[242:243], s[42:43], v[34:35]
    v_pk_fma_f32 v[244:245], v[244:245], s[42:43], v[34:35]
    v_pk_fma_f32 v[246:247], v[246:247], s[42:43], v[34:35]
    v_pk_fma_f32 v[248:249], v[248:249], s[42:43], v[34:35]
    v_pk_fma_f32 v[250:251], v[250:251], s[42:43], v[34:35]
    v_pk_fma_f32 v[252:253], v[252:253], s[42:43], v[34:35]
    v_pk_fma_f32 v[254:255], v[254:255], s[42:43], v[34:35]
    v_exp_f32 v240, v240
    v_exp_f32 v241, v241
    v_exp_f32 v242, v242
    v_exp_f32 v243, v243
    v_exp_f32 v244, v244
    v_exp_f32 v245, v245
    v_exp_f32 v246, v246
    v_exp_f32 v247, v247
    v_exp_f32 v248, v248
    v_exp_f32 v249, v249
    v_exp_f32 v250, v250
    v_exp_f32 v251, v251
    v_exp_f32 v252, v252
    v_exp_f32 v253, v253
    v_exp_f32 v254, v254
    v_exp_f32 v255, v255
    v_pk_add_f32 v[32:33], v[240:241], v[242:243]
    v_pk_add_f32 v[32:33], v[32:33], v[244:245]
    v_pk_add_f32 v[32:33], v[32:33], v[246:247]
    v_pk_add_f32 v[32:33], v[32:33], v[248:249]
    v_pk_add_f32 v[32:33], v[32:33], v[250:251]
    v_pk_add_f32 v[32:33], v[32:33], v[252:253]
    v_pk_add_f32 v[32:33], v[32:33], v[254:255]
    v_add_f32 v37, v32, v33
    v_max3_f32 v32, v24, v25, v26
    v_max3_f32 v32, v32, v27, v28
    v_max3_f32 v32, v32, v29, v31
    v_max_f32 v32, v32, v23
    v_mov_b32 v33, v32
    s_nop 1
    v_permlane32_swap_b32 v32, v33
    s_nop 1
    v_max_f32 v32, v32, v33
    v_sub_f32 v24, v24, v32
    v_sub_f32 v25, v25, v32
    v_sub_f32 v26, v26, v32
    v_sub_f32 v27, v27, v32
    v_sub_f32 v28, v28, v32
    v_sub_f32 v29, v29, v32
    v_sub_f32 v31, v31, v32
    v_sub_f32 v23, v23, v32
    v_mul_f32 v24, s50, v24
    v_mul_f32 v25, s50, v25
    v_mul_f32 v26, s50, v26
    v_mul_f32 v27, s50, v27
    v_mul_f32 v28, s50, v28
    v_mul_f32 v29, s50, v29
    v_mul_f32 v31, s50, v31
    v_mul_f32 v23, s50, v23
    v_exp_f32 v24, v24
    v_exp_f32 v25, v25
    v_exp_f32 v26, v26
    v_exp_f32 v27, v27
    v_exp_f32 v28, v28
    v_exp_f32 v29, v29
    v_exp_f32 v31, v31
    v_exp_f32 v23, v23
    s_nop 0
    v_mul_f32 v34, v24, v18
    v_fma_f32 v34, v25, v19, v34
    v_fma_f32 v34, v26, v20, v34
    v_fma_f32 v34, v27, v21, v34
    v_fma_f32 v34, v28, v0, v34
    v_fma_f32 v34, v29, v38, v34
    v_fma_f32 v34, v31, v39, v34
    v_fma_f32 v34, v23, v37, v34
    v_mov_b32 v35, v34
    s_nop 1
    v_permlane32_swap_b32 v34, v35
    s_nop 1
    v_add_f32 v34, v34, v35
    v_and_b32 v35, 31, v1
    v_lshlrev_b32 v35, 3, v35
    s_lshl_b32 s3, s28, 8
    s_add_u32 s48, s3, 0
    s_xor_b32 s3, s3, 256
    s_add_u32 s3, s3, 0
    v_add_u32 v36, s48, v35
    v_add_u32 v37, s3, v35
    ds_write_b32 v36, v32
    ds_write_b32 v36, v34 offset:4
    s_waitcnt lgkmcnt(0)
    s_barrier
    ds_read_b64 v[38:39], v37
    s_waitcnt lgkmcnt(0)
    v_max_f32 v35, v32, v38
    v_sub_f32 v36, v32, v35
    v_sub_f32 v37, v38, v35
    v_mul_f32 v36, s50, v36
    v_mul_f32 v37, s50, v37
    v_exp_f32 v36, v36
    v_exp_f32 v37, v37
    s_nop 0
    v_mul_f32 v35, v34, v36
    v_fma_f32 v35, v39, v37, v35
    v_rcp_f32 v35, v35
    s_nop 0
    v_mul_f32 v35, v35, v36
    v_mul_f32 v36, v35, v24
    v_mul_f32 v37, v35, v24
    v_pk_mul_f32 v[128:129], v[128:129], v[36:37]
    v_pk_mul_f32 v[130:131], v[130:131], v[36:37]
    v_pk_mul_f32 v[132:133], v[132:133], v[36:37]
    v_pk_mul_f32 v[134:135], v[134:135], v[36:37]
    v_pk_mul_f32 v[136:137], v[136:137], v[36:37]
    v_pk_mul_f32 v[138:139], v[138:139], v[36:37]
    v_pk_mul_f32 v[140:141], v[140:141], v[36:37]
    v_pk_mul_f32 v[142:143], v[142:143], v[36:37]
    v_cvt_pk_bf16_f32 v64, v128, v129
    v_cvt_pk_bf16_f32 v65, v130, v131
    v_cvt_pk_bf16_f32 v66, v132, v133
    v_cvt_pk_bf16_f32 v67, v134, v135
    v_cvt_pk_bf16_f32 v68, v136, v137
    v_cvt_pk_bf16_f32 v69, v138, v139
    v_cvt_pk_bf16_f32 v70, v140, v141
    v_cvt_pk_bf16_f32 v71, v142, v143
    v_mul_f32 v36, v35, v25
    v_mul_f32 v37, v35, v25
    v_pk_mul_f32 v[144:145], v[144:145], v[36:37]
    v_pk_mul_f32 v[146:147], v[146:147], v[36:37]
    v_pk_mul_f32 v[148:149], v[148:149], v[36:37]
    v_pk_mul_f32 v[150:151], v[150:151], v[36:37]
    v_pk_mul_f32 v[152:153], v[152:153], v[36:37]
    v_pk_mul_f32 v[154:155], v[154:155], v[36:37]
    v_pk_mul_f32 v[156:157], v[156:157], v[36:37]
    v_pk_mul_f32 v[158:159], v[158:159], v[36:37]
    v_cvt_pk_bf16_f32 v72, v144, v145
    v_cvt_pk_bf16_f32 v73, v146, v147
    v_cvt_pk_bf16_f32 v74, v148, v149
    v_cvt_pk_bf16_f32 v75, v150, v151
    v_cvt_pk_bf16_f32 v76, v152, v153
    v_cvt_pk_bf16_f32 v77, v154, v155
    v_cvt_pk_bf16_f32 v78, v156, v157
    v_cvt_pk_bf16_f32 v79, v158, v159
    v_mul_f32 v36, v35, v26
    v_mul_f32 v37, v35, v26
    v_pk_mul_f32 v[160:161], v[160:161], v[36:37]
    v_pk_mul_f32 v[162:163], v[162:163], v[36:37]
    v_pk_mul_f32 v[164:165], v[164:165], v[36:37]
    v_pk_mul_f32 v[166:167], v[166:167], v[36:37]
    v_pk_mul_f32 v[168:169], v[168:169], v[36:37]
    v_pk_mul_f32 v[170:171], v[170:171], v[36:37]
    v_pk_mul_f32 v[172:173], v[172:173], v[36:37]
    v_pk_mul_f32 v[174:175], v[174:175], v[36:37]
    v_cvt_pk_bf16_f32 v80, v160, v161
    v_cvt_pk_bf16_f32 v81, v162, v163
    v_cvt_pk_bf16_f32 v82, v164, v165
    v_cvt_pk_bf16_f32 v83, v166, v167
    v_cvt_pk_bf16_f32 v84, v168, v169
    v_cvt_pk_bf16_f32 v85, v170, v171
    v_cvt_pk_bf16_f32 v86, v172, v173
    v_cvt_pk_bf16_f32 v87, v174, v175
    v_mul_f32 v36, v35, v27
    v_mul_f32 v37, v35, v27
    v_pk_mul_f32 v[176:177], v[176:177], v[36:37]
    v_pk_mul_f32 v[178:179], v[178:179], v[36:37]
    v_pk_mul_f32 v[180:181], v[180:181], v[36:37]
    v_pk_mul_f32 v[182:183], v[182:183], v[36:37]
    v_pk_mul_f32 v[184:185], v[184:185], v[36:37]
    v_pk_mul_f32 v[186:187], v[186:187], v[36:37]
    v_pk_mul_f32 v[188:189], v[188:189], v[36:37]
    v_pk_mul_f32 v[190:191], v[190:191], v[36:37]
    v_cvt_pk_bf16_f32 v88, v176, v177
    v_cvt_pk_bf16_f32 v89, v178, v179
    v_cvt_pk_bf16_f32 v90, v180, v181
    v_cvt_pk_bf16_f32 v91, v182, v183
    v_cvt_pk_bf16_f32 v92, v184, v185
    v_cvt_pk_bf16_f32 v93, v186, v187
    v_cvt_pk_bf16_f32 v94, v188, v189
    v_cvt_pk_bf16_f32 v95, v190, v191
    v_mul_f32 v36, v35, v28
    v_mul_f32 v37, v35, v28
    v_pk_mul_f32 v[192:193], v[192:193], v[36:37]
    v_pk_mul_f32 v[194:195], v[194:195], v[36:37]
    v_pk_mul_f32 v[196:197], v[196:197], v[36:37]
    v_pk_mul_f32 v[198:199], v[198:199], v[36:37]
    v_pk_mul_f32 v[200:201], v[200:201], v[36:37]
    v_pk_mul_f32 v[202:203], v[202:203], v[36:37]
    v_pk_mul_f32 v[204:205], v[204:205], v[36:37]
    v_pk_mul_f32 v[206:207], v[206:207], v[36:37]
    v_cvt_pk_bf16_f32 v96, v192, v193
    v_cvt_pk_bf16_f32 v97, v194, v195
    v_cvt_pk_bf16_f32 v98, v196, v197
    v_cvt_pk_bf16_f32 v99, v198, v199
    v_cvt_pk_bf16_f32 v100, v200, v201
    v_cvt_pk_bf16_f32 v101, v202, v203
    v_cvt_pk_bf16_f32 v102, v204, v205
    v_cvt_pk_bf16_f32 v103, v206, v207
    v_mul_f32 v36, v35, v29
    v_mul_f32 v37, v35, v29
    v_pk_mul_f32 v[208:209], v[208:209], v[36:37]
    v_pk_mul_f32 v[210:211], v[210:211], v[36:37]
    v_pk_mul_f32 v[212:213], v[212:213], v[36:37]
    v_pk_mul_f32 v[214:215], v[214:215], v[36:37]
    v_pk_mul_f32 v[216:217], v[216:217], v[36:37]
    v_pk_mul_f32 v[218:219], v[218:219], v[36:37]
    v_pk_mul_f32 v[220:221], v[220:221], v[36:37]
    v_pk_mul_f32 v[222:223], v[222:223], v[36:37]
    v_cvt_pk_bf16_f32 v104, v208, v209
    v_cvt_pk_bf16_f32 v105, v210, v211
    v_cvt_pk_bf16_f32 v106, v212, v213
    v_cvt_pk_bf16_f32 v107, v214, v215
    v_cvt_pk_bf16_f32 v108, v216, v217
    v_cvt_pk_bf16_f32 v109, v218, v219
    v_cvt_pk_bf16_f32 v110, v220, v221
    v_cvt_pk_bf16_f32 v111, v222, v223
    v_mul_f32 v36, v35, v31
    v_mul_f32 v37, v35, v31
    v_pk_mul_f32 v[224:225], v[224:225], v[36:37]
    v_pk_mul_f32 v[226:227], v[226:227], v[36:37]
    v_pk_mul_f32 v[228:229], v[228:229], v[36:37]
    v_pk_mul_f32 v[230:231], v[230:231], v[36:37]
    v_pk_mul_f32 v[232:233], v[232:233], v[36:37]
    v_pk_mul_f32 v[234:235], v[234:235], v[36:37]
    v_pk_mul_f32 v[236:237], v[236:237], v[36:37]
    v_pk_mul_f32 v[238:239], v[238:239], v[36:37]
    v_cvt_pk_bf16_f32 v112, v224, v225
    v_cvt_pk_bf16_f32 v113, v226, v227
    v_cvt_pk_bf16_f32 v114, v228, v229
    v_cvt_pk_bf16_f32 v115, v230, v231
    v_cvt_pk_bf16_f32 v116, v232, v233
    v_cvt_pk_bf16_f32 v117, v234, v235
    v_cvt_pk_bf16_f32 v118, v236, v237
    v_cvt_pk_bf16_f32 v119, v238, v239
    v_mul_f32 v36, v35, v23
    v_mul_f32 v37, v35, v23
    v_pk_mul_f32 v[240:241], v[240:241], v[36:37]
    v_pk_mul_f32 v[242:243], v[242:243], v[36:37]
    v_pk_mul_f32 v[244:245], v[244:245], v[36:37]
    v_pk_mul_f32 v[246:247], v[246:247], v[36:37]
    v_pk_mul_f32 v[248:249], v[248:249], v[36:37]
    v_pk_mul_f32 v[250:251], v[250:251], v[36:37]
    v_pk_mul_f32 v[252:253], v[252:253], v[36:37]
    v_pk_mul_f32 v[254:255], v[254:255], v[36:37]
    v_cvt_pk_bf16_f32 v120, v240, v241
    v_cvt_pk_bf16_f32 v121, v242, v243
    v_cvt_pk_bf16_f32 v122, v244, v245
    v_cvt_pk_bf16_f32 v123, v246, v247
    v_cvt_pk_bf16_f32 v124, v248, v249
    v_cvt_pk_bf16_f32 v125, v250, v251
    v_cvt_pk_bf16_f32 v126, v252, v253
    v_cvt_pk_bf16_f32 v127, v254, v255
    s_barrier
    s_mov_b32 s49, 32768
    s_cmp_eq_u32 s30, 0
    s_cselect_b32 s3, 16384, s49
    v_add_u32 v10, s3, v10
    v_add_u32 v11, s3, v11
    v_add_u32 v12, s3, v12
    v_add_u32 v13, s3, v13
    v_add_u32 v14, s3, v14
    v_add_u32 v15, s3, v15
    v_add_u32 v16, s3, v16
    v_add_u32 v17, s3, v17
    ds_read_b64_tr_b16 v[40:41], v10 offset:0
    ds_read_b64_tr_b16 v[42:43], v10 offset:2048
    ds_read_b64_tr_b16 v[44:45], v11 offset:0
    ds_read_b64_tr_b16 v[46:47], v11 offset:2048
    ds_read_b64_tr_b16 v[48:49], v12 offset:0
    ds_read_b64_tr_b16 v[50:51], v12 offset:2048
    ds_read_b64_tr_b16 v[52:53], v13 offset:0
    ds_read_b64_tr_b16 v[54:55], v13 offset:2048
    ds_read_b64_tr_b16 v[56:57], v14 offset:0
    ds_read_b64_tr_b16 v[58:59], v14 offset:2048
    ds_read_b64_tr_b16 v[60:61], v15 offset:0
    ds_read_b64_tr_b16 v[62:63], v15 offset:2048
    s_waitcnt lgkmcnt(10)
    v_mfma_f32_32x32x16_bf16 v[128:143], v[40:43], v[64:67], 0
    ds_read_b64_tr_b16 v[40:41], v16 offset:0
    ds_read_b64_tr_b16 v[42:43], v16 offset:2048
    s_waitcnt lgkmcnt(10)
    v_mfma_f32_32x32x16_bf16 v[144:159], v[44:47], v[64:67], 0
    ds_read_b64_tr_b16 v[44:45], v17 offset:0
    ds_read_b64_tr_b16 v[46:47], v17 offset:2048
    s_waitcnt lgkmcnt(10)
    v_mfma_f32_32x32x16_bf16 v[160:175], v[48:51], v[64:67], 0
    ds_read_b64_tr_b16 v[48:49], v10 offset:8192
    ds_read_b64_tr_b16 v[50:51], v10 offset:10240
    s_waitcnt lgkmcnt(10)
    v_mfma_f32_32x32x16_bf16 v[176:191], v[52:55], v[64:67], 0
    ds_read_b64_tr_b16 v[52:53], v11 offset:8192
    ds_read_b64_tr_b16 v[54:55], v11 offset:10240
    s_waitcnt lgkmcnt(10)
    v_mfma_f32_32x32x16_bf16 v[192:207], v[56:59], v[64:67], 0
    ds_read_b64_tr_b16 v[56:57], v12 offset:8192
    ds_read_b64_tr_b16 v[58:59], v12 offset:10240
    s_waitcnt lgkmcnt(10)
    v_mfma_f32_32x32x16_bf16 v[208:223], v[60:63], v[64:67], 0
    ds_read_b64_tr_b16 v[60:61], v13 offset:8192
    ds_read_b64_tr_b16 v[62:63], v13 offset:10240
    s_waitcnt lgkmcnt(10)
    v_mfma_f32_32x32x16_bf16 v[224:239], v[40:43], v[64:67], 0
    ds_read_b64_tr_b16 v[40:41], v14 offset:8192
    ds_read_b64_tr_b16 v[42:43], v14 offset:10240
    s_waitcnt lgkmcnt(10)
    v_mfma_f32_32x32x16_bf16 v[240:255], v[44:47], v[64:67], 0
    ds_read_b64_tr_b16 v[44:45], v15 offset:8192
    ds_read_b64_tr_b16 v[46:47], v15 offset:10240
    s_waitcnt lgkmcnt(10)
    v_mfma_f32_32x32x16_bf16 v[128:143], v[48:51], v[68:71], v[128:143]
    ds_read_b64_tr_b16 v[48:49], v16 offset:8192
    ds_read_b64_tr_b16 v[50:51], v16 offset:10240
    s_waitcnt lgkmcnt(10)
    v_mfma_f32_32x32x16_bf16 v[144:159], v[52:55], v[68:71], v[144:159]
    ds_read_b64_tr_b16 v[52:53], v17 offset:8192
    ds_read_b64_tr_b16 v[54:55], v17 offset:10240
    s_waitcnt lgkmcnt(10)
    v_mfma_f32_32x32x16_bf16 v[160:175], v[56:59], v[68:71], v[160:175]
    s_barrier
    s_mov_b32 s49, 98304
    s_cmp_eq_u32 s30, 0
    s_cselect_b32 s3, 32768, s49
    v_add_u32 v10, s3, v10
    v_add_u32 v11, s3, v11
    v_add_u32 v12, s3, v12
    v_add_u32 v13, s3, v13
    v_add_u32 v14, s3, v14
    v_add_u32 v15, s3, v15
    v_add_u32 v16, s3, v16
    v_add_u32 v17, s3, v17
    ds_read_b64_tr_b16 v[56:57], v10 offset:0
    ds_read_b64_tr_b16 v[58:59], v10 offset:2048
    s_waitcnt lgkmcnt(10)
    v_mfma_f32_32x32x16_bf16 v[176:191], v[60:63], v[68:71], v[176:191]
    ds_read_b64_tr_b16 v[60:61], v11 offset:0
    ds_read_b64_tr_b16 v[62:63], v11 offset:2048
    s_waitcnt lgkmcnt(10)
    v_mfma_f32_32x32x16_bf16 v[192:207], v[40:43], v[68:71], v[192:207]
    ds_read_b64_tr_b16 v[40:41], v12 offset:0
    ds_read_b64_tr_b16 v[42:43], v12 offset:2048
    s_waitcnt lgkmcnt(10)
    v_mfma_f32_32x32x16_bf16 v[208:223], v[44:47], v[68:71], v[208:223]
    ds_read_b64_tr_b16 v[44:45], v13 offset:0
    ds_read_b64_tr_b16 v[46:47], v13 offset:2048
    s_waitcnt lgkmcnt(10)
    v_mfma_f32_32x32x16_bf16 v[224:239], v[48:51], v[68:71], v[224:239]
    ds_read_b64_tr_b16 v[48:49], v14 offset:0
    ds_read_b64_tr_b16 v[50:51], v14 offset:2048
    s_waitcnt lgkmcnt(10)
    v_mfma_f32_32x32x16_bf16 v[240:255], v[52:55], v[68:71], v[240:255]
    ds_read_b64_tr_b16 v[52:53], v15 offset:0
    ds_read_b64_tr_b16 v[54:55], v15 offset:2048
    s_waitcnt lgkmcnt(10)
    v_mfma_f32_32x32x16_bf16 v[128:143], v[56:59], v[72:75], v[128:143]
    ds_read_b64_tr_b16 v[56:57], v16 offset:0
    ds_read_b64_tr_b16 v[58:59], v16 offset:2048
    s_waitcnt lgkmcnt(10)
    v_mfma_f32_32x32x16_bf16 v[144:159], v[60:63], v[72:75], v[144:159]
    ds_read_b64_tr_b16 v[60:61], v17 offset:0
    ds_read_b64_tr_b16 v[62:63], v17 offset:2048
    s_waitcnt lgkmcnt(10)
    v_mfma_f32_32x32x16_bf16 v[160:175], v[40:43], v[72:75], v[160:175]
    ds_read_b64_tr_b16 v[40:41], v10 offset:8192
    ds_read_b64_tr_b16 v[42:43], v10 offset:10240
    s_waitcnt lgkmcnt(10)
    v_mfma_f32_32x32x16_bf16 v[176:191], v[44:47], v[72:75], v[176:191]
    ds_read_b64_tr_b16 v[44:45], v11 offset:8192
    ds_read_b64_tr_b16 v[46:47], v11 offset:10240
    s_waitcnt lgkmcnt(10)
    v_mfma_f32_32x32x16_bf16 v[192:207], v[48:51], v[72:75], v[192:207]
    ds_read_b64_tr_b16 v[48:49], v12 offset:8192
    ds_read_b64_tr_b16 v[50:51], v12 offset:10240
    s_waitcnt lgkmcnt(10)
    v_mfma_f32_32x32x16_bf16 v[208:223], v[52:55], v[72:75], v[208:223]
    ds_read_b64_tr_b16 v[52:53], v13 offset:8192
    ds_read_b64_tr_b16 v[54:55], v13 offset:10240
    s_waitcnt lgkmcnt(10)
    v_mfma_f32_32x32x16_bf16 v[224:239], v[56:59], v[72:75], v[224:239]
    ds_read_b64_tr_b16 v[56:57], v14 offset:8192
    ds_read_b64_tr_b16 v[58:59], v14 offset:10240
    s_waitcnt lgkmcnt(10)
    v_mfma_f32_32x32x16_bf16 v[240:255], v[60:63], v[72:75], v[240:255]
    ds_read_b64_tr_b16 v[60:61], v15 offset:8192
    ds_read_b64_tr_b16 v[62:63], v15 offset:10240
    s_waitcnt lgkmcnt(10)
    v_mfma_f32_32x32x16_bf16 v[128:143], v[40:43], v[76:79], v[128:143]
    ds_read_b64_tr_b16 v[40:41], v16 offset:8192
    ds_read_b64_tr_b16 v[42:43], v16 offset:10240
    s_waitcnt lgkmcnt(10)
    v_mfma_f32_32x32x16_bf16 v[144:159], v[44:47], v[76:79], v[144:159]
    ds_read_b64_tr_b16 v[44:45], v17 offset:8192
    ds_read_b64_tr_b16 v[46:47], v17 offset:10240
    s_waitcnt lgkmcnt(10)
    v_mfma_f32_32x32x16_bf16 v[160:175], v[48:51], v[76:79], v[160:175]
    s_barrier
    s_mov_b32 s49, 4294901760
    s_cmp_eq_u32 s30, 0
    s_cselect_b32 s3, 98304, s49
    v_add_u32 v10, s3, v10
    v_add_u32 v11, s3, v11
    v_add_u32 v12, s3, v12
    v_add_u32 v13, s3, v13
    v_add_u32 v14, s3, v14
    v_add_u32 v15, s3, v15
    v_add_u32 v16, s3, v16
    v_add_u32 v17, s3, v17
    ds_read_b64_tr_b16 v[48:49], v10 offset:0
    ds_read_b64_tr_b16 v[50:51], v10 offset:2048
    s_waitcnt lgkmcnt(10)
    v_mfma_f32_32x32x16_bf16 v[176:191], v[52:55], v[76:79], v[176:191]
    ds_read_b64_tr_b16 v[52:53], v11 offset:0
    ds_read_b64_tr_b16 v[54:55], v11 offset:2048
    s_waitcnt lgkmcnt(10)
    v_mfma_f32_32x32x16_bf16 v[192:207], v[56:59], v[76:79], v[192:207]
    ds_read_b64_tr_b16 v[56:57], v12 offset:0
    ds_read_b64_tr_b16 v[58:59], v12 offset:2048
    s_waitcnt lgkmcnt(10)
    v_mfma_f32_32x32x16_bf16 v[208:223], v[60:63], v[76:79], v[208:223]
    ds_read_b64_tr_b16 v[60:61], v13 offset:0
    ds_read_b64_tr_b16 v[62:63], v13 offset:2048
    s_waitcnt lgkmcnt(10)
    v_mfma_f32_32x32x16_bf16 v[224:239], v[40:43], v[76:79], v[224:239]
    ds_read_b64_tr_b16 v[40:41], v14 offset:0
    ds_read_b64_tr_b16 v[42:43], v14 offset:2048
    s_waitcnt lgkmcnt(10)
    v_mfma_f32_32x32x16_bf16 v[240:255], v[44:47], v[76:79], v[240:255]
    ds_read_b64_tr_b16 v[44:45], v15 offset:0
    ds_read_b64_tr_b16 v[46:47], v15 offset:2048
    s_waitcnt lgkmcnt(10)
    v_mfma_f32_32x32x16_bf16 v[128:143], v[48:51], v[80:83], v[128:143]
    ds_read_b64_tr_b16 v[48:49], v16 offset:0
    ds_read_b64_tr_b16 v[50:51], v16 offset:2048
    s_waitcnt lgkmcnt(10)
    v_mfma_f32_32x32x16_bf16 v[144:159], v[52:55], v[80:83], v[144:159]
    ds_read_b64_tr_b16 v[52:53], v17 offset:0
    ds_read_b64_tr_b16 v[54:55], v17 offset:2048
    s_waitcnt lgkmcnt(10)
    v_mfma_f32_32x32x16_bf16 v[160:175], v[56:59], v[80:83], v[160:175]
    ds_read_b64_tr_b16 v[56:57], v10 offset:8192
    ds_read_b64_tr_b16 v[58:59], v10 offset:10240
    s_waitcnt lgkmcnt(10)
    v_mfma_f32_32x32x16_bf16 v[176:191], v[60:63], v[80:83], v[176:191]
    ds_read_b64_tr_b16 v[60:61], v11 offset:8192
    ds_read_b64_tr_b16 v[62:63], v11 offset:10240
    s_waitcnt lgkmcnt(10)
    v_mfma_f32_32x32x16_bf16 v[192:207], v[40:43], v[80:83], v[192:207]
    ds_read_b64_tr_b16 v[40:41], v12 offset:8192
    ds_read_b64_tr_b16 v[42:43], v12 offset:10240
    s_waitcnt lgkmcnt(10)
    v_mfma_f32_32x32x16_bf16 v[208:223], v[44:47], v[80:83], v[208:223]
    ds_read_b64_tr_b16 v[44:45], v13 offset:8192
    ds_read_b64_tr_b16 v[46:47], v13 offset:10240
    s_waitcnt lgkmcnt(10)
    v_mfma_f32_32x32x16_bf16 v[224:239], v[48:51], v[80:83], v[224:239]
    ds_read_b64_tr_b16 v[48:49], v14 offset:8192
    ds_read_b64_tr_b16 v[50:51], v14 offset:10240
    s_waitcnt lgkmcnt(10)
    v_mfma_f32_32x32x16_bf16 v[240:255], v[52:55], v[80:83], v[240:255]
    ds_read_b64_tr_b16 v[52:53], v15 offset:8192
    ds_read_b64_tr_b16 v[54:55], v15 offset:10240
    s_waitcnt lgkmcnt(10)
    v_mfma_f32_32x32x16_bf16 v[128:143], v[56:59], v[84:87], v[128:143]
    ds_read_b64_tr_b16 v[56:57], v16 offset:8192
    ds_read_b64_tr_b16 v[58:59], v16 offset:10240
    s_waitcnt lgkmcnt(10)
    v_mfma_f32_32x32x16_bf16 v[144:159], v[60:63], v[84:87], v[144:159]
    ds_read_b64_tr_b16 v[60:61], v17 offset:8192
    ds_read_b64_tr_b16 v[62:63], v17 offset:10240
    s_waitcnt lgkmcnt(10)
    v_mfma_f32_32x32x16_bf16 v[160:175], v[40:43], v[84:87], v[160:175]
    s_barrier
    s_mov_b32 s49, 32768
    s_cmp_eq_u32 s30, 0
    s_cselect_b32 s3, 4294901760, s49
    v_add_u32 v10, s3, v10
    v_add_u32 v11, s3, v11
    v_add_u32 v12, s3, v12
    v_add_u32 v13, s3, v13
    v_add_u32 v14, s3, v14
    v_add_u32 v15, s3, v15
    v_add_u32 v16, s3, v16
    v_add_u32 v17, s3, v17
    ds_read_b64_tr_b16 v[40:41], v10 offset:0
    ds_read_b64_tr_b16 v[42:43], v10 offset:2048
    s_waitcnt lgkmcnt(10)
    v_mfma_f32_32x32x16_bf16 v[176:191], v[44:47], v[84:87], v[176:191]
    ds_read_b64_tr_b16 v[44:45], v11 offset:0
    ds_read_b64_tr_b16 v[46:47], v11 offset:2048
    s_waitcnt lgkmcnt(10)
    v_mfma_f32_32x32x16_bf16 v[192:207], v[48:51], v[84:87], v[192:207]
    ds_read_b64_tr_b16 v[48:49], v12 offset:0
    ds_read_b64_tr_b16 v[50:51], v12 offset:2048
    s_waitcnt lgkmcnt(10)
    v_mfma_f32_32x32x16_bf16 v[208:223], v[52:55], v[84:87], v[208:223]
    ds_read_b64_tr_b16 v[52:53], v13 offset:0
    ds_read_b64_tr_b16 v[54:55], v13 offset:2048
    s_waitcnt lgkmcnt(10)
    v_mfma_f32_32x32x16_bf16 v[224:239], v[56:59], v[84:87], v[224:239]
    ds_read_b64_tr_b16 v[56:57], v14 offset:0
    ds_read_b64_tr_b16 v[58:59], v14 offset:2048
    s_waitcnt lgkmcnt(10)
    v_mfma_f32_32x32x16_bf16 v[240:255], v[60:63], v[84:87], v[240:255]
    ds_read_b64_tr_b16 v[60:61], v15 offset:0
    ds_read_b64_tr_b16 v[62:63], v15 offset:2048
    s_waitcnt lgkmcnt(10)
    v_mfma_f32_32x32x16_bf16 v[128:143], v[40:43], v[88:91], v[128:143]
    ds_read_b64_tr_b16 v[40:41], v16 offset:0
    ds_read_b64_tr_b16 v[42:43], v16 offset:2048
    s_waitcnt lgkmcnt(10)
    v_mfma_f32_32x32x16_bf16 v[144:159], v[44:47], v[88:91], v[144:159]
    ds_read_b64_tr_b16 v[44:45], v17 offset:0
    ds_read_b64_tr_b16 v[46:47], v17 offset:2048
    s_waitcnt lgkmcnt(10)
    v_mfma_f32_32x32x16_bf16 v[160:175], v[48:51], v[88:91], v[160:175]
    ds_read_b64_tr_b16 v[48:49], v10 offset:8192
    ds_read_b64_tr_b16 v[50:51], v10 offset:10240
    s_waitcnt lgkmcnt(10)
    v_mfma_f32_32x32x16_bf16 v[176:191], v[52:55], v[88:91], v[176:191]
    ds_read_b64_tr_b16 v[52:53], v11 offset:8192
    ds_read_b64_tr_b16 v[54:55], v11 offset:10240
    s_waitcnt lgkmcnt(10)
    v_mfma_f32_32x32x16_bf16 v[192:207], v[56:59], v[88:91], v[192:207]
    ds_read_b64_tr_b16 v[56:57], v12 offset:8192
    ds_read_b64_tr_b16 v[58:59], v12 offset:10240
    s_waitcnt lgkmcnt(10)
    v_mfma_f32_32x32x16_bf16 v[208:223], v[60:63], v[88:91], v[208:223]
    ds_read_b64_tr_b16 v[60:61], v13 offset:8192
    ds_read_b64_tr_b16 v[62:63], v13 offset:10240
    s_waitcnt lgkmcnt(10)
    v_mfma_f32_32x32x16_bf16 v[224:239], v[40:43], v[88:91], v[224:239]
    ds_read_b64_tr_b16 v[40:41], v14 offset:8192
    ds_read_b64_tr_b16 v[42:43], v14 offset:10240
    s_waitcnt lgkmcnt(10)
    v_mfma_f32_32x32x16_bf16 v[240:255], v[44:47], v[88:91], v[240:255]
    ds_read_b64_tr_b16 v[44:45], v15 offset:8192
    ds_read_b64_tr_b16 v[46:47], v15 offset:10240
    s_waitcnt lgkmcnt(10)
    v_mfma_f32_32x32x16_bf16 v[128:143], v[48:51], v[92:95], v[128:143]
    ds_read_b64_tr_b16 v[48:49], v16 offset:8192
    ds_read_b64_tr_b16 v[50:51], v16 offset:10240
    s_waitcnt lgkmcnt(10)
    v_mfma_f32_32x32x16_bf16 v[144:159], v[52:55], v[92:95], v[144:159]
    ds_read_b64_tr_b16 v[52:53], v17 offset:8192
    ds_read_b64_tr_b16 v[54:55], v17 offset:10240
    s_waitcnt lgkmcnt(10)
    v_mfma_f32_32x32x16_bf16 v[160:175], v[56:59], v[92:95], v[160:175]
    s_barrier
    s_mov_b32 s49, 4294868992
    s_cmp_eq_u32 s30, 0
    s_cselect_b32 s3, 32768, s49
    v_add_u32 v10, s3, v10
    v_add_u32 v11, s3, v11
    v_add_u32 v12, s3, v12
    v_add_u32 v13, s3, v13
    v_add_u32 v14, s3, v14
    v_add_u32 v15, s3, v15
    v_add_u32 v16, s3, v16
    v_add_u32 v17, s3, v17
    ds_read_b64_tr_b16 v[56:57], v10 offset:0
    ds_read_b64_tr_b16 v[58:59], v10 offset:2048
    s_waitcnt lgkmcnt(10)
    v_mfma_f32_32x32x16_bf16 v[176:191], v[60:63], v[92:95], v[176:191]
    ds_read_b64_tr_b16 v[60:61], v11 offset:0
    ds_read_b64_tr_b16 v[62:63], v11 offset:2048
    s_waitcnt lgkmcnt(10)
    v_mfma_f32_32x32x16_bf16 v[192:207], v[40:43], v[92:95], v[192:207]
    ds_read_b64_tr_b16 v[40:41], v12 offset:0
    ds_read_b64_tr_b16 v[42:43], v12 offset:2048
    s_waitcnt lgkmcnt(10)
    v_mfma_f32_32x32x16_bf16 v[208:223], v[44:47], v[92:95], v[208:223]
    ds_read_b64_tr_b16 v[44:45], v13 offset:0
    ds_read_b64_tr_b16 v[46:47], v13 offset:2048
    s_waitcnt lgkmcnt(10)
    v_mfma_f32_32x32x16_bf16 v[224:239], v[48:51], v[92:95], v[224:239]
    ds_read_b64_tr_b16 v[48:49], v14 offset:0
    ds_read_b64_tr_b16 v[50:51], v14 offset:2048
    s_waitcnt lgkmcnt(10)
    v_mfma_f32_32x32x16_bf16 v[240:255], v[52:55], v[92:95], v[240:255]
    ds_read_b64_tr_b16 v[52:53], v15 offset:0
    ds_read_b64_tr_b16 v[54:55], v15 offset:2048
    s_waitcnt lgkmcnt(10)
    v_mfma_f32_32x32x16_bf16 v[128:143], v[56:59], v[96:99], v[128:143]
    ds_read_b64_tr_b16 v[56:57], v16 offset:0
    ds_read_b64_tr_b16 v[58:59], v16 offset:2048
    s_waitcnt lgkmcnt(10)
    v_mfma_f32_32x32x16_bf16 v[144:159], v[60:63], v[96:99], v[144:159]
    ds_read_b64_tr_b16 v[60:61], v17 offset:0
    ds_read_b64_tr_b16 v[62:63], v17 offset:2048
    s_waitcnt lgkmcnt(10)
    v_mfma_f32_32x32x16_bf16 v[160:175], v[40:43], v[96:99], v[160:175]
    ds_read_b64_tr_b16 v[40:41], v10 offset:8192
    ds_read_b64_tr_b16 v[42:43], v10 offset:10240
    s_waitcnt lgkmcnt(10)
    v_mfma_f32_32x32x16_bf16 v[176:191], v[44:47], v[96:99], v[176:191]
    ds_read_b64_tr_b16 v[44:45], v11 offset:8192
    ds_read_b64_tr_b16 v[46:47], v11 offset:10240
    s_waitcnt lgkmcnt(10)
    v_mfma_f32_32x32x16_bf16 v[192:207], v[48:51], v[96:99], v[192:207]
    ds_read_b64_tr_b16 v[48:49], v12 offset:8192
    ds_read_b64_tr_b16 v[50:51], v12 offset:10240
    s_waitcnt lgkmcnt(10)
    v_mfma_f32_32x32x16_bf16 v[208:223], v[52:55], v[96:99], v[208:223]
    ds_read_b64_tr_b16 v[52:53], v13 offset:8192
    ds_read_b64_tr_b16 v[54:55], v13 offset:10240
    s_waitcnt lgkmcnt(10)
    v_mfma_f32_32x32x16_bf16 v[224:239], v[56:59], v[96:99], v[224:239]
    ds_read_b64_tr_b16 v[56:57], v14 offset:8192
    ds_read_b64_tr_b16 v[58:59], v14 offset:10240
    s_waitcnt lgkmcnt(10)
    v_mfma_f32_32x32x16_bf16 v[240:255], v[60:63], v[96:99], v[240:255]
    ds_read_b64_tr_b16 v[60:61], v15 offset:8192
    ds_read_b64_tr_b16 v[62:63], v15 offset:10240
    s_waitcnt lgkmcnt(10)
    v_mfma_f32_32x32x16_bf16 v[128:143], v[40:43], v[100:103], v[128:143]
    ds_read_b64_tr_b16 v[40:41], v16 offset:8192
    ds_read_b64_tr_b16 v[42:43], v16 offset:10240
    s_waitcnt lgkmcnt(10)
    v_mfma_f32_32x32x16_bf16 v[144:159], v[44:47], v[100:103], v[144:159]
    ds_read_b64_tr_b16 v[44:45], v17 offset:8192
    ds_read_b64_tr_b16 v[46:47], v17 offset:10240
    s_waitcnt lgkmcnt(10)
    v_mfma_f32_32x32x16_bf16 v[160:175], v[48:51], v[100:103], v[160:175]
    s_barrier
    s_mov_b32 s49, 32768
    s_cmp_eq_u32 s30, 0
    s_cselect_b32 s3, 4294868992, s49
    v_add_u32 v10, s3, v10
    v_add_u32 v11, s3, v11
    v_add_u32 v12, s3, v12
    v_add_u32 v13, s3, v13
    v_add_u32 v14, s3, v14
    v_add_u32 v15, s3, v15
    v_add_u32 v16, s3, v16
    v_add_u32 v17, s3, v17
    ds_read_b64_tr_b16 v[48:49], v10 offset:0
    ds_read_b64_tr_b16 v[50:51], v10 offset:2048
    s_waitcnt lgkmcnt(10)
    v_mfma_f32_32x32x16_bf16 v[176:191], v[52:55], v[100:103], v[176:191]
    ds_read_b64_tr_b16 v[52:53], v11 offset:0
    ds_read_b64_tr_b16 v[54:55], v11 offset:2048
    s_waitcnt lgkmcnt(10)
    v_mfma_f32_32x32x16_bf16 v[192:207], v[56:59], v[100:103], v[192:207]
    ds_read_b64_tr_b16 v[56:57], v12 offset:0
    ds_read_b64_tr_b16 v[58:59], v12 offset:2048
    s_waitcnt lgkmcnt(10)
    v_mfma_f32_32x32x16_bf16 v[208:223], v[60:63], v[100:103], v[208:223]
    ds_read_b64_tr_b16 v[60:61], v13 offset:0
    ds_read_b64_tr_b16 v[62:63], v13 offset:2048
    s_waitcnt lgkmcnt(10)
    v_mfma_f32_32x32x16_bf16 v[224:239], v[40:43], v[100:103], v[224:239]
    ds_read_b64_tr_b16 v[40:41], v14 offset:0
    ds_read_b64_tr_b16 v[42:43], v14 offset:2048
    s_waitcnt lgkmcnt(10)
    v_mfma_f32_32x32x16_bf16 v[240:255], v[44:47], v[100:103], v[240:255]
    ds_read_b64_tr_b16 v[44:45], v15 offset:0
    ds_read_b64_tr_b16 v[46:47], v15 offset:2048
    s_waitcnt lgkmcnt(10)
    v_mfma_f32_32x32x16_bf16 v[128:143], v[48:51], v[104:107], v[128:143]
    ds_read_b64_tr_b16 v[48:49], v16 offset:0
    ds_read_b64_tr_b16 v[50:51], v16 offset:2048
    s_waitcnt lgkmcnt(10)
    v_mfma_f32_32x32x16_bf16 v[144:159], v[52:55], v[104:107], v[144:159]
    ds_read_b64_tr_b16 v[52:53], v17 offset:0
    ds_read_b64_tr_b16 v[54:55], v17 offset:2048
    s_waitcnt lgkmcnt(10)
    v_mfma_f32_32x32x16_bf16 v[160:175], v[56:59], v[104:107], v[160:175]
    ds_read_b64_tr_b16 v[56:57], v10 offset:8192
    ds_read_b64_tr_b16 v[58:59], v10 offset:10240
    s_waitcnt lgkmcnt(10)
    v_mfma_f32_32x32x16_bf16 v[176:191], v[60:63], v[104:107], v[176:191]
    ds_read_b64_tr_b16 v[60:61], v11 offset:8192
    ds_read_b64_tr_b16 v[62:63], v11 offset:10240
    s_waitcnt lgkmcnt(10)
    v_mfma_f32_32x32x16_bf16 v[192:207], v[40:43], v[104:107], v[192:207]
    ds_read_b64_tr_b16 v[40:41], v12 offset:8192
    ds_read_b64_tr_b16 v[42:43], v12 offset:10240
    s_waitcnt lgkmcnt(10)
    v_mfma_f32_32x32x16_bf16 v[208:223], v[44:47], v[104:107], v[208:223]
    ds_read_b64_tr_b16 v[44:45], v13 offset:8192
    ds_read_b64_tr_b16 v[46:47], v13 offset:10240
    s_waitcnt lgkmcnt(10)
    v_mfma_f32_32x32x16_bf16 v[224:239], v[48:51], v[104:107], v[224:239]
    ds_read_b64_tr_b16 v[48:49], v14 offset:8192
    ds_read_b64_tr_b16 v[50:51], v14 offset:10240
    s_waitcnt lgkmcnt(10)
    v_mfma_f32_32x32x16_bf16 v[240:255], v[52:55], v[104:107], v[240:255]
    ds_read_b64_tr_b16 v[52:53], v15 offset:8192
    ds_read_b64_tr_b16 v[54:55], v15 offset:10240
    s_waitcnt lgkmcnt(10)
    v_mfma_f32_32x32x16_bf16 v[128:143], v[56:59], v[108:111], v[128:143]
    ds_read_b64_tr_b16 v[56:57], v16 offset:8192
    ds_read_b64_tr_b16 v[58:59], v16 offset:10240
    s_waitcnt lgkmcnt(10)
    v_mfma_f32_32x32x16_bf16 v[144:159], v[60:63], v[108:111], v[144:159]
    ds_read_b64_tr_b16 v[60:61], v17 offset:8192
    ds_read_b64_tr_b16 v[62:63], v17 offset:10240
    s_waitcnt lgkmcnt(10)
    v_mfma_f32_32x32x16_bf16 v[160:175], v[40:43], v[108:111], v[160:175]
    s_barrier
    s_mov_b32 s49, 98304
    s_cmp_eq_u32 s30, 0
    s_cselect_b32 s3, 32768, s49
    v_add_u32 v10, s3, v10
    v_add_u32 v11, s3, v11
    v_add_u32 v12, s3, v12
    v_add_u32 v13, s3, v13
    v_add_u32 v14, s3, v14
    v_add_u32 v15, s3, v15
    v_add_u32 v16, s3, v16
    v_add_u32 v17, s3, v17
    ds_read_b64_tr_b16 v[40:41], v10 offset:0
    ds_read_b64_tr_b16 v[42:43], v10 offset:2048
    s_waitcnt lgkmcnt(10)
    v_mfma_f32_32x32x16_bf16 v[176:191], v[44:47], v[108:111], v[176:191]
    ds_read_b64_tr_b16 v[44:45], v11 offset:0
    ds_read_b64_tr_b16 v[46:47], v11 offset:2048
    s_waitcnt lgkmcnt(10)
    v_mfma_f32_32x32x16_bf16 v[192:207], v[48:51], v[108:111], v[192:207]
    ds_read_b64_tr_b16 v[48:49], v12 offset:0
    ds_read_b64_tr_b16 v[50:51], v12 offset:2048
    s_waitcnt lgkmcnt(10)
    v_mfma_f32_32x32x16_bf16 v[208:223], v[52:55], v[108:111], v[208:223]
    ds_read_b64_tr_b16 v[52:53], v13 offset:0
    ds_read_b64_tr_b16 v[54:55], v13 offset:2048
    s_waitcnt lgkmcnt(10)
    v_mfma_f32_32x32x16_bf16 v[224:239], v[56:59], v[108:111], v[224:239]
    ds_read_b64_tr_b16 v[56:57], v14 offset:0
    ds_read_b64_tr_b16 v[58:59], v14 offset:2048
    s_waitcnt lgkmcnt(10)
    v_mfma_f32_32x32x16_bf16 v[240:255], v[60:63], v[108:111], v[240:255]
    ds_read_b64_tr_b16 v[60:61], v15 offset:0
    ds_read_b64_tr_b16 v[62:63], v15 offset:2048
    s_waitcnt lgkmcnt(10)
    v_mfma_f32_32x32x16_bf16 v[128:143], v[40:43], v[112:115], v[128:143]
    ds_read_b64_tr_b16 v[40:41], v16 offset:0
    ds_read_b64_tr_b16 v[42:43], v16 offset:2048
    s_waitcnt lgkmcnt(10)
    v_mfma_f32_32x32x16_bf16 v[144:159], v[44:47], v[112:115], v[144:159]
    ds_read_b64_tr_b16 v[44:45], v17 offset:0
    ds_read_b64_tr_b16 v[46:47], v17 offset:2048
    s_waitcnt lgkmcnt(10)
    v_mfma_f32_32x32x16_bf16 v[160:175], v[48:51], v[112:115], v[160:175]
    ds_read_b64_tr_b16 v[48:49], v10 offset:8192
    ds_read_b64_tr_b16 v[50:51], v10 offset:10240
    s_waitcnt lgkmcnt(10)
    v_mfma_f32_32x32x16_bf16 v[176:191], v[52:55], v[112:115], v[176:191]
    ds_read_b64_tr_b16 v[52:53], v11 offset:8192
    ds_read_b64_tr_b16 v[54:55], v11 offset:10240
    s_waitcnt lgkmcnt(10)
    v_mfma_f32_32x32x16_bf16 v[192:207], v[56:59], v[112:115], v[192:207]
    ds_read_b64_tr_b16 v[56:57], v12 offset:8192
    ds_read_b64_tr_b16 v[58:59], v12 offset:10240
    s_waitcnt lgkmcnt(10)
    v_mfma_f32_32x32x16_bf16 v[208:223], v[60:63], v[112:115], v[208:223]
    ds_read_b64_tr_b16 v[60:61], v13 offset:8192
    ds_read_b64_tr_b16 v[62:63], v13 offset:10240
    s_waitcnt lgkmcnt(10)
    v_mfma_f32_32x32x16_bf16 v[224:239], v[40:43], v[112:115], v[224:239]
    ds_read_b64_tr_b16 v[40:41], v14 offset:8192
    ds_read_b64_tr_b16 v[42:43], v14 offset:10240
    s_waitcnt lgkmcnt(10)
    v_mfma_f32_32x32x16_bf16 v[240:255], v[44:47], v[112:115], v[240:255]
    ds_read_b64_tr_b16 v[44:45], v15 offset:8192
    ds_read_b64_tr_b16 v[46:47], v15 offset:10240
    s_waitcnt lgkmcnt(10)
    v_mfma_f32_32x32x16_bf16 v[128:143], v[48:51], v[116:119], v[128:143]
    ds_read_b64_tr_b16 v[48:49], v16 offset:8192
    ds_read_b64_tr_b16 v[50:51], v16 offset:10240
    s_waitcnt lgkmcnt(10)
    v_mfma_f32_32x32x16_bf16 v[144:159], v[52:55], v[116:119], v[144:159]
    ds_read_b64_tr_b16 v[52:53], v17 offset:8192
    ds_read_b64_tr_b16 v[54:55], v17 offset:10240
    s_waitcnt lgkmcnt(10)
    v_mfma_f32_32x32x16_bf16 v[160:175], v[56:59], v[116:119], v[160:175]
    s_barrier
    s_mov_b32 s49, 4294901760
    s_cmp_eq_u32 s30, 0
    s_cselect_b32 s3, 98304, s49
    v_add_u32 v10, s3, v10
    v_add_u32 v11, s3, v11
    v_add_u32 v12, s3, v12
    v_add_u32 v13, s3, v13
    v_add_u32 v14, s3, v14
    v_add_u32 v15, s3, v15
    v_add_u32 v16, s3, v16
    v_add_u32 v17, s3, v17
    ds_read_b64_tr_b16 v[56:57], v10 offset:0
    ds_read_b64_tr_b16 v[58:59], v10 offset:2048
    s_waitcnt lgkmcnt(10)
    v_mfma_f32_32x32x16_bf16 v[176:191], v[60:63], v[116:119], v[176:191]
    ds_read_b64_tr_b16 v[60:61], v11 offset:0
    ds_read_b64_tr_b16 v[62:63], v11 offset:2048
    s_waitcnt lgkmcnt(10)
    v_mfma_f32_32x32x16_bf16 v[192:207], v[40:43], v[116:119], v[192:207]
    ds_read_b64_tr_b16 v[40:41], v12 offset:0
    ds_read_b64_tr_b16 v[42:43], v12 offset:2048
    s_waitcnt lgkmcnt(10)
    v_mfma_f32_32x32x16_bf16 v[208:223], v[44:47], v[116:119], v[208:223]
    ds_read_b64_tr_b16 v[44:45], v13 offset:0
    ds_read_b64_tr_b16 v[46:47], v13 offset:2048
    s_waitcnt lgkmcnt(10)
    v_mfma_f32_32x32x16_bf16 v[224:239], v[48:51], v[116:119], v[224:239]
    ds_read_b64_tr_b16 v[48:49], v14 offset:0
    ds_read_b64_tr_b16 v[50:51], v14 offset:2048
    s_waitcnt lgkmcnt(10)
    v_mfma_f32_32x32x16_bf16 v[240:255], v[52:55], v[116:119], v[240:255]
    ds_read_b64_tr_b16 v[52:53], v15 offset:0
    ds_read_b64_tr_b16 v[54:55], v15 offset:2048
    s_waitcnt lgkmcnt(10)
    v_mfma_f32_32x32x16_bf16 v[128:143], v[56:59], v[120:123], v[128:143]
    ds_read_b64_tr_b16 v[56:57], v16 offset:0
    ds_read_b64_tr_b16 v[58:59], v16 offset:2048
    s_waitcnt lgkmcnt(10)
    v_mfma_f32_32x32x16_bf16 v[144:159], v[60:63], v[120:123], v[144:159]
    ds_read_b64_tr_b16 v[60:61], v17 offset:0
    ds_read_b64_tr_b16 v[62:63], v17 offset:2048
    s_waitcnt lgkmcnt(10)
    v_mfma_f32_32x32x16_bf16 v[160:175], v[40:43], v[120:123], v[160:175]
    ds_read_b64_tr_b16 v[40:41], v10 offset:8192
    ds_read_b64_tr_b16 v[42:43], v10 offset:10240
    s_waitcnt lgkmcnt(10)
    v_mfma_f32_32x32x16_bf16 v[176:191], v[44:47], v[120:123], v[176:191]
    ds_read_b64_tr_b16 v[44:45], v11 offset:8192
    ds_read_b64_tr_b16 v[46:47], v11 offset:10240
    s_waitcnt lgkmcnt(10)
    v_mfma_f32_32x32x16_bf16 v[192:207], v[48:51], v[120:123], v[192:207]
    ds_read_b64_tr_b16 v[48:49], v12 offset:8192
    ds_read_b64_tr_b16 v[50:51], v12 offset:10240
    s_waitcnt lgkmcnt(10)
    v_mfma_f32_32x32x16_bf16 v[208:223], v[52:55], v[120:123], v[208:223]
    ds_read_b64_tr_b16 v[52:53], v13 offset:8192
    ds_read_b64_tr_b16 v[54:55], v13 offset:10240
    s_waitcnt lgkmcnt(10)
    v_mfma_f32_32x32x16_bf16 v[224:239], v[56:59], v[120:123], v[224:239]
    ds_read_b64_tr_b16 v[56:57], v14 offset:8192
    ds_read_b64_tr_b16 v[58:59], v14 offset:10240
    s_waitcnt lgkmcnt(10)
    v_mfma_f32_32x32x16_bf16 v[240:255], v[60:63], v[120:123], v[240:255]
    ds_read_b64_tr_b16 v[60:61], v15 offset:8192
    ds_read_b64_tr_b16 v[62:63], v15 offset:10240
    s_waitcnt lgkmcnt(10)
    v_mfma_f32_32x32x16_bf16 v[128:143], v[40:43], v[124:127], v[128:143]
    ds_read_b64_tr_b16 v[40:41], v16 offset:8192
    ds_read_b64_tr_b16 v[42:43], v16 offset:10240
    s_waitcnt lgkmcnt(10)
    v_mfma_f32_32x32x16_bf16 v[144:159], v[44:47], v[124:127], v[144:159]
    ds_read_b64_tr_b16 v[44:45], v17 offset:8192
    ds_read_b64_tr_b16 v[46:47], v17 offset:10240
    s_waitcnt lgkmcnt(10)
    v_mfma_f32_32x32x16_bf16 v[160:175], v[48:51], v[124:127], v[160:175]
    s_waitcnt lgkmcnt(8)
    v_mfma_f32_32x32x16_bf16 v[176:191], v[52:55], v[124:127], v[176:191]
    s_waitcnt lgkmcnt(6)
    v_mfma_f32_32x32x16_bf16 v[192:207], v[56:59], v[124:127], v[192:207]
    s_waitcnt lgkmcnt(4)
    v_mfma_f32_32x32x16_bf16 v[208:223], v[60:63], v[124:127], v[208:223]
    s_waitcnt lgkmcnt(2)
    v_mfma_f32_32x32x16_bf16 v[224:239], v[40:43], v[124:127], v[224:239]
    s_waitcnt lgkmcnt(0)
    v_mfma_f32_32x32x16_bf16 v[240:255], v[44:47], v[124:127], v[240:255]
    s_nop 15
    s_barrier
    s_mov_b32 s48, 131072
    s_mov_b32 s49, 65536
    s_cmp_eq_u32 s30, 0
    s_cselect_b32 s37, 49152, s48
    s_cselect_b32 s38, 147456, s49
    s_cselect_b32 s39, s48, 49152
    s_cselect_b32 s40, s49, 147456
    s_cmp_eq_u32 s29, 0
    s_cselect_b32 s37, s37, s38
    s_cselect_b32 s39, s39, s40
    v_add_u32 v34, s37, v30
    v_add_u32 v35, s39, v30
    ds_write_b128 v34, v[192:195] offset:0
    ds_write_b128 v34, v[196:199] offset:1024
    ds_write_b128 v34, v[200:203] offset:2048
    ds_write_b128 v34, v[204:207] offset:3072
    ds_write_b128 v34, v[208:211] offset:4096
    ds_write_b128 v34, v[212:215] offset:5120
    ds_write_b128 v34, v[216:219] offset:6144
    ds_write_b128 v34, v[220:223] offset:7168
    ds_write_b128 v34, v[224:227] offset:8192
    ds_write_b128 v34, v[228:231] offset:9216
    ds_write_b128 v34, v[232:235] offset:10240
    ds_write_b128 v34, v[236:239] offset:11264
    ds_write_b128 v34, v[240:243] offset:12288
    ds_write_b128 v34, v[244:247] offset:13312
    ds_write_b128 v34, v[248:251] offset:14336
    ds_write_b128 v34, v[252:255] offset:15360
    s_waitcnt lgkmcnt(0)
    s_barrier
    ds_read_b128 v[192:195], v35 offset:0
    ds_read_b128 v[196:199], v35 offset:1024
    ds_read_b128 v[200:203], v35 offset:2048
    ds_read_b128 v[204:207], v35 offset:3072
    ds_read_b128 v[208:211], v35 offset:4096
    ds_read_b128 v[212:215], v35 offset:5120
    ds_read_b128 v[216:219], v35 offset:6144
    ds_read_b128 v[220:223], v35 offset:7168
    ds_read_b128 v[224:227], v35 offset:8192
    ds_read_b128 v[228:231], v35 offset:9216
    ds_read_b128 v[232:235], v35 offset:10240
    ds_read_b128 v[236:239], v35 offset:11264
    ds_read_b128 v[240:243], v35 offset:12288
    ds_read_b128 v[244:247], v35 offset:13312
    ds_read_b128 v[248:251], v35 offset:14336
    ds_read_b128 v[252:255], v35 offset:15360
    s_waitcnt lgkmcnt(15)
    v_add_f32 v128, v128, v192
    v_add_f32 v129, v129, v193
    v_add_f32 v130, v130, v194
    v_add_f32 v131, v131, v195
    s_waitcnt lgkmcnt(14)
    v_add_f32 v132, v132, v196
    v_add_f32 v133, v133, v197
    v_add_f32 v134, v134, v198
    v_add_f32 v135, v135, v199
    s_waitcnt lgkmcnt(13)
    v_add_f32 v136, v136, v200
    v_add_f32 v137, v137, v201
    v_add_f32 v138, v138, v202
    v_add_f32 v139, v139, v203
    s_waitcnt lgkmcnt(12)
    v_add_f32 v140, v140, v204
    v_add_f32 v141, v141, v205
    v_add_f32 v142, v142, v206
    v_add_f32 v143, v143, v207
    s_waitcnt lgkmcnt(11)
    v_add_f32 v144, v144, v208
    v_add_f32 v145, v145, v209
    v_add_f32 v146, v146, v210
    v_add_f32 v147, v147, v211
    s_waitcnt lgkmcnt(10)
    v_add_f32 v148, v148, v212
    v_add_f32 v149, v149, v213
    v_add_f32 v150, v150, v214
    v_add_f32 v151, v151, v215
    s_waitcnt lgkmcnt(9)
    v_add_f32 v152, v152, v216
    v_add_f32 v153, v153, v217
    v_add_f32 v154, v154, v218
    v_add_f32 v155, v155, v219
    s_waitcnt lgkmcnt(8)
    v_add_f32 v156, v156, v220
    v_add_f32 v157, v157, v221
    v_add_f32 v158, v158, v222
    v_add_f32 v159, v159, v223
    s_waitcnt lgkmcnt(7)
    v_add_f32 v160, v160, v224
    v_add_f32 v161, v161, v225
    v_add_f32 v162, v162, v226
    v_add_f32 v163, v163, v227
    s_waitcnt lgkmcnt(6)
    v_add_f32 v164, v164, v228
    v_add_f32 v165, v165, v229
    v_add_f32 v166, v166, v230
    v_add_f32 v167, v167, v231
    s_waitcnt lgkmcnt(5)
    v_add_f32 v168, v168, v232
    v_add_f32 v169, v169, v233
    v_add_f32 v170, v170, v234
    v_add_f32 v171, v171, v235
    s_waitcnt lgkmcnt(4)
    v_add_f32 v172, v172, v236
    v_add_f32 v173, v173, v237
    v_add_f32 v174, v174, v238
    v_add_f32 v175, v175, v239
    s_waitcnt lgkmcnt(3)
    v_add_f32 v176, v176, v240
    v_add_f32 v177, v177, v241
    v_add_f32 v178, v178, v242
    v_add_f32 v179, v179, v243
    s_waitcnt lgkmcnt(2)
    v_add_f32 v180, v180, v244
    v_add_f32 v181, v181, v245
    v_add_f32 v182, v182, v246
    v_add_f32 v183, v183, v247
    s_waitcnt lgkmcnt(1)
    v_add_f32 v184, v184, v248
    v_add_f32 v185, v185, v249
    v_add_f32 v186, v186, v250
    v_add_f32 v187, v187, v251
    s_waitcnt lgkmcnt(0)
    v_add_f32 v188, v188, v252
    v_add_f32 v189, v189, v253
    v_add_f32 v190, v190, v254
    v_add_f32 v191, v191, v255
    v_cvt_pk_bf16_f32 v64, v128, v129
    v_cvt_pk_bf16_f32 v65, v130, v131
    v_cvt_pk_bf16_f32 v66, v132, v133
    v_cvt_pk_bf16_f32 v67, v134, v135
    v_cvt_pk_bf16_f32 v68, v136, v137
    v_cvt_pk_bf16_f32 v69, v138, v139
    v_cvt_pk_bf16_f32 v70, v140, v141
    v_cvt_pk_bf16_f32 v71, v142, v143
    v_cvt_pk_bf16_f32 v72, v144, v145
    v_cvt_pk_bf16_f32 v73, v146, v147
    v_cvt_pk_bf16_f32 v74, v148, v149
    v_cvt_pk_bf16_f32 v75, v150, v151
    v_cvt_pk_bf16_f32 v76, v152, v153
    v_cvt_pk_bf16_f32 v77, v154, v155
    v_cvt_pk_bf16_f32 v78, v156, v157
    v_cvt_pk_bf16_f32 v79, v158, v159
    v_cvt_pk_bf16_f32 v80, v160, v161
    v_cvt_pk_bf16_f32 v81, v162, v163
    v_cvt_pk_bf16_f32 v82, v164, v165
    v_cvt_pk_bf16_f32 v83, v166, v167
    v_cvt_pk_bf16_f32 v84, v168, v169
    v_cvt_pk_bf16_f32 v85, v170, v171
    v_cvt_pk_bf16_f32 v86, v172, v173
    v_cvt_pk_bf16_f32 v87, v174, v175
    v_cvt_pk_bf16_f32 v88, v176, v177
    v_cvt_pk_bf16_f32 v89, v178, v179
    v_cvt_pk_bf16_f32 v90, v180, v181
    v_cvt_pk_bf16_f32 v91, v182, v183
    v_cvt_pk_bf16_f32 v92, v184, v185
    v_cvt_pk_bf16_f32 v93, v186, v187
    v_cvt_pk_bf16_f32 v94, v188, v189
    v_cvt_pk_bf16_f32 v95, v190, v191
    ds_write_b128 v35, v[64:67] offset:0
    ds_write_b128 v35, v[68:71] offset:1024
    ds_write_b128 v35, v[72:75] offset:2048
    ds_write_b128 v35, v[76:79] offset:3072
    ds_write_b128 v35, v[80:83] offset:4096
    ds_write_b128 v35, v[84:87] offset:5120
    ds_write_b128 v35, v[88:91] offset:6144
    ds_write_b128 v35, v[92:95] offset:7168
    s_cmp_eq_u32 s30, 0
    s_cselect_b32 s48, s39, s37
    s_cselect_b32 s49, s37, s39
    v_add_u32 v32, s48, v30
    v_add_u32 v33, s49, v30
    s_waitcnt lgkmcnt(0)
    s_barrier
    ds_read_b128 v[64:67], v32 offset:0
    ds_read_b128 v[68:71], v32 offset:1024
    ds_read_b128 v[72:75], v32 offset:2048
    ds_read_b128 v[76:79], v32 offset:3072
    ds_read_b128 v[80:83], v32 offset:4096
    ds_read_b128 v[84:87], v32 offset:5120
    ds_read_b128 v[88:91], v32 offset:6144
    ds_read_b128 v[92:95], v32 offset:7168
    ds_read_b128 v[96:99], v33 offset:0
    ds_read_b128 v[100:103], v33 offset:1024
    ds_read_b128 v[104:107], v33 offset:2048
    ds_read_b128 v[108:111], v33 offset:3072
    ds_read_b128 v[112:115], v33 offset:4096
    ds_read_b128 v[116:119], v33 offset:5120
    ds_read_b128 v[120:123], v33 offset:6144
    ds_read_b128 v[124:127], v33 offset:7168
    s_waitcnt lgkmcnt(0)
    s_barrier
    s_mov_b32 s3, 81920
    v_add_u32 v22, s3, v22
    ds_read_b64_tr_b16 v[48:49], v22 offset:0
    ds_read_b64_tr_b16 v[50:51], v22 offset:512
    ds_read_b64_tr_b16 v[52:53], v22 offset:2048
    ds_read_b64_tr_b16 v[54:55], v22 offset:2560
    ds_read_b64_tr_b16 v[56:57], v22 offset:4096
    ds_read_b64_tr_b16 v[58:59], v22 offset:4608
    ds_read_b64_tr_b16 v[60:61], v22 offset:6144
    ds_read_b64_tr_b16 v[62:63], v22 offset:6656
    ds_read_b64_tr_b16 v[40:41], v22 offset:8192
    ds_read_b64_tr_b16 v[42:43], v22 offset:8704
    ds_read_b64_tr_b16 v[44:45], v22 offset:10240
    ds_read_b64_tr_b16 v[46:47], v22 offset:10752
    s_waitcnt lgkmcnt(10)
    v_mfma_f32_32x32x16_bf16 v[128:143], v[48:51], v[64:67], 0
    ds_read_b64_tr_b16 v[48:49], v22 offset:12288
    ds_read_b64_tr_b16 v[50:51], v22 offset:12800
    s_waitcnt lgkmcnt(10)
    v_mfma_f32_32x32x16_bf16 v[128:143], v[52:55], v[68:71], v[128:143]
    ds_read_b64_tr_b16 v[52:53], v22 offset:14336
    ds_read_b64_tr_b16 v[54:55], v22 offset:14848
    s_waitcnt lgkmcnt(10)
    v_mfma_f32_32x32x16_bf16 v[128:143], v[56:59], v[72:75], v[128:143]
    ds_read_b64_tr_b16 v[56:57], v22 offset:16384
    ds_read_b64_tr_b16 v[58:59], v22 offset:16896
    s_waitcnt lgkmcnt(10)
    v_mfma_f32_32x32x16_bf16 v[128:143], v[60:63], v[76:79], v[128:143]
    ds_read_b64_tr_b16 v[60:61], v22 offset:18432
    ds_read_b64_tr_b16 v[62:63], v22 offset:18944
    s_waitcnt lgkmcnt(10)
    v_mfma_f32_32x32x16_bf16 v[128:143], v[40:43], v[80:83], v[128:143]
    ds_read_b64_tr_b16 v[40:41], v22 offset:20480
    ds_read_b64_tr_b16 v[42:43], v22 offset:20992
    s_waitcnt lgkmcnt(10)
    v_mfma_f32_32x32x16_bf16 v[128:143], v[44:47], v[84:87], v[128:143]
    ds_read_b64_tr_b16 v[44:45], v22 offset:22528
    ds_read_b64_tr_b16 v[46:47], v22 offset:23040
    s_waitcnt lgkmcnt(10)
    v_mfma_f32_32x32x16_bf16 v[128:143], v[48:51], v[88:91], v[128:143]
    ds_read_b64_tr_b16 v[48:49], v22 offset:24576
    ds_read_b64_tr_b16 v[50:51], v22 offset:25088
    s_waitcnt lgkmcnt(10)
    v_mfma_f32_32x32x16_bf16 v[128:143], v[52:55], v[92:95], v[128:143]
    ds_read_b64_tr_b16 v[52:53], v22 offset:26624
    ds_read_b64_tr_b16 v[54:55], v22 offset:27136
    s_waitcnt lgkmcnt(10)
    v_mfma_f32_32x32x16_bf16 v[128:143], v[56:59], v[96:99], v[128:143]
    ds_read_b64_tr_b16 v[56:57], v22 offset:28672
    ds_read_b64_tr_b16 v[58:59], v22 offset:29184
    s_waitcnt lgkmcnt(10)
    v_mfma_f32_32x32x16_bf16 v[128:143], v[60:63], v[100:103], v[128:143]
    ds_read_b64_tr_b16 v[60:61], v22 offset:30720
    ds_read_b64_tr_b16 v[62:63], v22 offset:31232
    s_waitcnt lgkmcnt(10)
    v_mfma_f32_32x32x16_bf16 v[128:143], v[40:43], v[104:107], v[128:143]
    s_barrier
    ds_read_b64_tr_b16 v[40:41], v22 offset:32768
    ds_read_b64_tr_b16 v[42:43], v22 offset:33280
    s_waitcnt lgkmcnt(10)
    v_mfma_f32_32x32x16_bf16 v[128:143], v[44:47], v[108:111], v[128:143]
    ds_read_b64_tr_b16 v[44:45], v22 offset:34816
    ds_read_b64_tr_b16 v[46:47], v22 offset:35328
    s_waitcnt lgkmcnt(10)
    v_mfma_f32_32x32x16_bf16 v[128:143], v[48:51], v[112:115], v[128:143]
    ds_read_b64_tr_b16 v[48:49], v22 offset:36864
    ds_read_b64_tr_b16 v[50:51], v22 offset:37376
    s_waitcnt lgkmcnt(10)
    v_mfma_f32_32x32x16_bf16 v[128:143], v[52:55], v[116:119], v[128:143]
    ds_read_b64_tr_b16 v[52:53], v22 offset:38912
    ds_read_b64_tr_b16 v[54:55], v22 offset:39424
    s_waitcnt lgkmcnt(10)
    v_mfma_f32_32x32x16_bf16 v[128:143], v[56:59], v[120:123], v[128:143]
    ds_read_b64_tr_b16 v[56:57], v22 offset:40960
    ds_read_b64_tr_b16 v[58:59], v22 offset:41472
    s_waitcnt lgkmcnt(10)
    v_mfma_f32_32x32x16_bf16 v[128:143], v[60:63], v[124:127], v[128:143]
    ds_read_b64_tr_b16 v[60:61], v22 offset:43008
    ds_read_b64_tr_b16 v[62:63], v22 offset:43520
    s_waitcnt lgkmcnt(10)
    v_mfma_f32_32x32x16_bf16 v[144:159], v[40:43], v[64:67], 0
    ds_read_b64_tr_b16 v[40:41], v22 offset:45056
    ds_read_b64_tr_b16 v[42:43], v22 offset:45568
    s_waitcnt lgkmcnt(10)
    v_mfma_f32_32x32x16_bf16 v[144:159], v[44:47], v[68:71], v[144:159]
    ds_read_b64_tr_b16 v[44:45], v22 offset:47104
    ds_read_b64_tr_b16 v[46:47], v22 offset:47616
    s_waitcnt lgkmcnt(10)
    v_mfma_f32_32x32x16_bf16 v[144:159], v[48:51], v[72:75], v[144:159]
    v_cvt_pk_bf16_f32 v128, v128, v129
    v_cvt_pk_bf16_f32 v129, v130, v131
    v_cvt_pk_bf16_f32 v130, v132, v133
    v_cvt_pk_bf16_f32 v131, v134, v135
    s_add_u32 s3, s97, 0
    s_sub_u32 s48, s3, 7
    s_cmp_ge_u32 s3, 7
    s_cselect_b32 s3, s48, s3
    s_lshl_b32 s3, s3, 11
    buffer_store_dwordx4 v[128:131], v30, s[24:27], s3 offen offset:0
    s_mov_b32 s3, 4294885376
    v_add_u32 v22, s3, v22
    ds_read_b64_tr_b16 v[48:49], v22 offset:0
    ds_read_b64_tr_b16 v[50:51], v22 offset:512
    s_waitcnt lgkmcnt(10)
    v_mfma_f32_32x32x16_bf16 v[144:159], v[52:55], v[76:79], v[144:159]
    v_cvt_pk_bf16_f32 v136, v136, v137
    v_cvt_pk_bf16_f32 v137, v138, v139
    v_cvt_pk_bf16_f32 v138, v140, v141
    v_cvt_pk_bf16_f32 v139, v142, v143
    s_add_u32 s3, s97, 0
    s_sub_u32 s48, s3, 7
    s_cmp_ge_u32 s3, 7
    s_cselect_b32 s3, s48, s3
    s_lshl_b32 s3, s3, 11
    buffer_store_dwordx4 v[136:139], v30, s[24:27], s3 offen offset:1024
    ds_read_b64_tr_b16 v[52:53], v22 offset:2048
    ds_read_b64_tr_b16 v[54:55], v22 offset:2560
    s_waitcnt lgkmcnt(10)
    v_mfma_f32_32x32x16_bf16 v[144:159], v[56:59], v[80:83], v[144:159]
    ds_read_b64_tr_b16 v[56:57], v22 offset:4096
    ds_read_b64_tr_b16 v[58:59], v22 offset:4608
    s_waitcnt lgkmcnt(10)
    v_mfma_f32_32x32x16_bf16 v[144:159], v[60:63], v[84:87], v[144:159]
    ds_read_b64_tr_b16 v[60:61], v22 offset:6144
    ds_read_b64_tr_b16 v[62:63], v22 offset:6656
    s_waitcnt lgkmcnt(10)
    v_mfma_f32_32x32x16_bf16 v[144:159], v[40:43], v[88:91], v[144:159]
    ds_read_b64_tr_b16 v[40:41], v22 offset:8192
    ds_read_b64_tr_b16 v[42:43], v22 offset:8704
    s_waitcnt lgkmcnt(10)
    v_mfma_f32_32x32x16_bf16 v[144:159], v[44:47], v[92:95], v[144:159]
    ds_read_b64_tr_b16 v[44:45], v22 offset:10240
    ds_read_b64_tr_b16 v[46:47], v22 offset:10752
    s_waitcnt lgkmcnt(10)
    v_mfma_f32_32x32x16_bf16 v[144:159], v[48:51], v[96:99], v[144:159]
    ds_read_b64_tr_b16 v[48:49], v22 offset:12288
    ds_read_b64_tr_b16 v[50:51], v22 offset:12800
    s_waitcnt lgkmcnt(10)
    v_mfma_f32_32x32x16_bf16 v[144:159], v[52:55], v[100:103], v[144:159]
    ds_read_b64_tr_b16 v[52:53], v22 offset:14336
    ds_read_b64_tr_b16 v[54:55], v22 offset:14848
    s_waitcnt lgkmcnt(10)
    v_mfma_f32_32x32x16_bf16 v[144:159], v[56:59], v[104:107], v[144:159]
    s_barrier
    ds_read_b64_tr_b16 v[56:57], v22 offset:16384
    ds_read_b64_tr_b16 v[58:59], v22 offset:16896
    s_waitcnt lgkmcnt(10)
    v_mfma_f32_32x32x16_bf16 v[144:159], v[60:63], v[108:111], v[144:159]
    ds_read_b64_tr_b16 v[60:61], v22 offset:18432
    ds_read_b64_tr_b16 v[62:63], v22 offset:18944
    s_waitcnt lgkmcnt(10)
    v_mfma_f32_32x32x16_bf16 v[144:159], v[40:43], v[112:115], v[144:159]
    ds_read_b64_tr_b16 v[40:41], v22 offset:20480
    ds_read_b64_tr_b16 v[42:43], v22 offset:20992
    s_waitcnt lgkmcnt(10)
    v_mfma_f32_32x32x16_bf16 v[144:159], v[44:47], v[116:119], v[144:159]
    ds_read_b64_tr_b16 v[44:45], v22 offset:22528
    ds_read_b64_tr_b16 v[46:47], v22 offset:23040
    s_waitcnt lgkmcnt(10)
    v_mfma_f32_32x32x16_bf16 v[144:159], v[48:51], v[120:123], v[144:159]
    ds_read_b64_tr_b16 v[48:49], v22 offset:24576
    ds_read_b64_tr_b16 v[50:51], v22 offset:25088
    s_waitcnt lgkmcnt(10)
    v_mfma_f32_32x32x16_bf16 v[144:159], v[52:55], v[124:127], v[144:159]
    ds_read_b64_tr_b16 v[52:53], v22 offset:26624
    ds_read_b64_tr_b16 v[54:55], v22 offset:27136
    s_waitcnt lgkmcnt(10)
    v_mfma_f32_32x32x16_bf16 v[160:175], v[56:59], v[64:67], 0
    ds_read_b64_tr_b16 v[56:57], v22 offset:28672
    ds_read_b64_tr_b16 v[58:59], v22 offset:29184
    s_waitcnt lgkmcnt(10)
    v_mfma_f32_32x32x16_bf16 v[160:175], v[60:63], v[68:71], v[160:175]
    ds_read_b64_tr_b16 v[60:61], v22 offset:30720
    ds_read_b64_tr_b16 v[62:63], v22 offset:31232
    s_waitcnt lgkmcnt(10)
    v_mfma_f32_32x32x16_bf16 v[160:175], v[40:43], v[72:75], v[160:175]
    v_cvt_pk_bf16_f32 v144, v144, v145
    v_cvt_pk_bf16_f32 v145, v146, v147
    v_cvt_pk_bf16_f32 v146, v148, v149
    v_cvt_pk_bf16_f32 v147, v150, v151
    s_add_u32 s3, s97, 1
    s_sub_u32 s48, s3, 7
    s_cmp_ge_u32 s3, 7
    s_cselect_b32 s3, s48, s3
    s_lshl_b32 s3, s3, 11
    buffer_store_dwordx4 v[144:147], v30, s[24:27], s3 offen offset:0
    ds_read_b64_tr_b16 v[40:41], v22 offset:32768
    ds_read_b64_tr_b16 v[42:43], v22 offset:33280
    s_waitcnt lgkmcnt(10)
    v_mfma_f32_32x32x16_bf16 v[160:175], v[44:47], v[76:79], v[160:175]
    v_cvt_pk_bf16_f32 v152, v152, v153
    v_cvt_pk_bf16_f32 v153, v154, v155
    v_cvt_pk_bf16_f32 v154, v156, v157
    v_cvt_pk_bf16_f32 v155, v158, v159
    s_add_u32 s3, s97, 1
    s_sub_u32 s48, s3, 7
    s_cmp_ge_u32 s3, 7
    s_cselect_b32 s3, s48, s3
    s_lshl_b32 s3, s3, 11
    buffer_store_dwordx4 v[152:155], v30, s[24:27], s3 offen offset:1024
    ds_read_b64_tr_b16 v[44:45], v22 offset:34816
    ds_read_b64_tr_b16 v[46:47], v22 offset:35328
    s_waitcnt lgkmcnt(10)
    v_mfma_f32_32x32x16_bf16 v[160:175], v[48:51], v[80:83], v[160:175]
    ds_read_b64_tr_b16 v[48:49], v22 offset:36864
    ds_read_b64_tr_b16 v[50:51], v22 offset:37376
    s_waitcnt lgkmcnt(10)
    v_mfma_f32_32x32x16_bf16 v[160:175], v[52:55], v[84:87], v[160:175]
    ds_read_b64_tr_b16 v[52:53], v22 offset:38912
    ds_read_b64_tr_b16 v[54:55], v22 offset:39424
    s_waitcnt lgkmcnt(10)
    v_mfma_f32_32x32x16_bf16 v[160:175], v[56:59], v[88:91], v[160:175]
    ds_read_b64_tr_b16 v[56:57], v22 offset:40960
    ds_read_b64_tr_b16 v[58:59], v22 offset:41472
    s_waitcnt lgkmcnt(10)
    v_mfma_f32_32x32x16_bf16 v[160:175], v[60:63], v[92:95], v[160:175]
    ds_read_b64_tr_b16 v[60:61], v22 offset:43008
    ds_read_b64_tr_b16 v[62:63], v22 offset:43520
    s_waitcnt lgkmcnt(10)
    v_mfma_f32_32x32x16_bf16 v[160:175], v[40:43], v[96:99], v[160:175]
    ds_read_b64_tr_b16 v[40:41], v22 offset:45056
    ds_read_b64_tr_b16 v[42:43], v22 offset:45568
    s_waitcnt lgkmcnt(10)
    v_mfma_f32_32x32x16_bf16 v[160:175], v[44:47], v[100:103], v[160:175]
    ds_read_b64_tr_b16 v[44:45], v22 offset:47104
    ds_read_b64_tr_b16 v[46:47], v22 offset:47616
    s_waitcnt lgkmcnt(10)
    v_mfma_f32_32x32x16_bf16 v[160:175], v[48:51], v[104:107], v[160:175]
    s_barrier
    s_mov_b32 s3, 49152
    v_add_u32 v22, s3, v22
    ds_read_b64_tr_b16 v[48:49], v22 offset:0
    ds_read_b64_tr_b16 v[50:51], v22 offset:512
    s_waitcnt lgkmcnt(10)
    v_mfma_f32_32x32x16_bf16 v[160:175], v[52:55], v[108:111], v[160:175]
    ds_read_b64_tr_b16 v[52:53], v22 offset:2048
    ds_read_b64_tr_b16 v[54:55], v22 offset:2560
    s_waitcnt lgkmcnt(10)
    v_mfma_f32_32x32x16_bf16 v[160:175], v[56:59], v[112:115], v[160:175]
    ds_read_b64_tr_b16 v[56:57], v22 offset:4096
    ds_read_b64_tr_b16 v[58:59], v22 offset:4608
    s_waitcnt lgkmcnt(10)
    v_mfma_f32_32x32x16_bf16 v[160:175], v[60:63], v[116:119], v[160:175]
    ds_read_b64_tr_b16 v[60:61], v22 offset:6144
    ds_read_b64_tr_b16 v[62:63], v22 offset:6656
    s_waitcnt lgkmcnt(10)
    v_mfma_f32_32x32x16_bf16 v[160:175], v[40:43], v[120:123], v[160:175]
    ds_read_b64_tr_b16 v[40:41], v22 offset:8192
    ds_read_b64_tr_b16 v[42:43], v22 offset:8704
    s_waitcnt lgkmcnt(10)
    v_mfma_f32_32x32x16_bf16 v[160:175], v[44:47], v[124:127], v[160:175]
    ds_read_b64_tr_b16 v[44:45], v22 offset:10240
    ds_read_b64_tr_b16 v[46:47], v22 offset:10752
    s_waitcnt lgkmcnt(10)
    v_mfma_f32_32x32x16_bf16 v[176:191], v[48:51], v[64:67], 0
    ds_read_b64_tr_b16 v[48:49], v22 offset:12288
    ds_read_b64_tr_b16 v[50:51], v22 offset:12800
    s_waitcnt lgkmcnt(10)
    v_mfma_f32_32x32x16_bf16 v[176:191], v[52:55], v[68:71], v[176:191]
    ds_read_b64_tr_b16 v[52:53], v22 offset:14336
    ds_read_b64_tr_b16 v[54:55], v22 offset:14848
    s_waitcnt lgkmcnt(10)
    v_mfma_f32_32x32x16_bf16 v[176:191], v[56:59], v[72:75], v[176:191]
    v_cvt_pk_bf16_f32 v160, v160, v161
    v_cvt_pk_bf16_f32 v161, v162, v163
    v_cvt_pk_bf16_f32 v162, v164, v165
    v_cvt_pk_bf16_f32 v163, v166, v167
    s_add_u32 s3, s97, 2
    s_sub_u32 s48, s3, 7
    s_cmp_ge_u32 s3, 7
    s_cselect_b32 s3, s48, s3
    s_lshl_b32 s3, s3, 11
    buffer_store_dwordx4 v[160:163], v30, s[24:27], s3 offen offset:0
    s_mov_b32 s3, 81920
    v_add_u32 v22, s3, v22
    ds_read_b64_tr_b16 v[56:57], v22 offset:0
    ds_read_b64_tr_b16 v[58:59], v22 offset:512
    s_waitcnt lgkmcnt(10)
    v_mfma_f32_32x32x16_bf16 v[176:191], v[60:63], v[76:79], v[176:191]
    v_cvt_pk_bf16_f32 v168, v168, v169
    v_cvt_pk_bf16_f32 v169, v170, v171
    v_cvt_pk_bf16_f32 v170, v172, v173
    v_cvt_pk_bf16_f32 v171, v174, v175
    s_add_u32 s3, s97, 2
    s_sub_u32 s48, s3, 7
    s_cmp_ge_u32 s3, 7
    s_cselect_b32 s3, s48, s3
    s_lshl_b32 s3, s3, 11
    buffer_store_dwordx4 v[168:171], v30, s[24:27], s3 offen offset:1024
    ds_read_b64_tr_b16 v[60:61], v22 offset:2048
    ds_read_b64_tr_b16 v[62:63], v22 offset:2560
    s_waitcnt lgkmcnt(10)
    v_mfma_f32_32x32x16_bf16 v[176:191], v[40:43], v[80:83], v[176:191]
    ds_read_b64_tr_b16 v[40:41], v22 offset:4096
    ds_read_b64_tr_b16 v[42:43], v22 offset:4608
    s_waitcnt lgkmcnt(10)
    v_mfma_f32_32x32x16_bf16 v[176:191], v[44:47], v[84:87], v[176:191]
    ds_read_b64_tr_b16 v[44:45], v22 offset:6144
    ds_read_b64_tr_b16 v[46:47], v22 offset:6656
    s_waitcnt lgkmcnt(10)
    v_mfma_f32_32x32x16_bf16 v[176:191], v[48:51], v[88:91], v[176:191]
    ds_read_b64_tr_b16 v[48:49], v22 offset:8192
    ds_read_b64_tr_b16 v[50:51], v22 offset:8704
    s_waitcnt lgkmcnt(10)
    v_mfma_f32_32x32x16_bf16 v[176:191], v[52:55], v[92:95], v[176:191]
    ds_read_b64_tr_b16 v[52:53], v22 offset:10240
    ds_read_b64_tr_b16 v[54:55], v22 offset:10752
    s_waitcnt lgkmcnt(10)
    v_mfma_f32_32x32x16_bf16 v[176:191], v[56:59], v[96:99], v[176:191]
    ds_read_b64_tr_b16 v[56:57], v22 offset:12288
    ds_read_b64_tr_b16 v[58:59], v22 offset:12800
    s_waitcnt lgkmcnt(10)
    v_mfma_f32_32x32x16_bf16 v[176:191], v[60:63], v[100:103], v[176:191]
    ds_read_b64_tr_b16 v[60:61], v22 offset:14336
    ds_read_b64_tr_b16 v[62:63], v22 offset:14848
    s_waitcnt lgkmcnt(10)
    v_mfma_f32_32x32x16_bf16 v[176:191], v[40:43], v[104:107], v[176:191]
    s_barrier
    ds_read_b64_tr_b16 v[40:41], v22 offset:16384
    ds_read_b64_tr_b16 v[42:43], v22 offset:16896
    s_waitcnt lgkmcnt(10)
    v_mfma_f32_32x32x16_bf16 v[176:191], v[44:47], v[108:111], v[176:191]
    ds_read_b64_tr_b16 v[44:45], v22 offset:18432
    ds_read_b64_tr_b16 v[46:47], v22 offset:18944
    s_waitcnt lgkmcnt(10)
    v_mfma_f32_32x32x16_bf16 v[176:191], v[48:51], v[112:115], v[176:191]
    ds_read_b64_tr_b16 v[48:49], v22 offset:20480
    ds_read_b64_tr_b16 v[50:51], v22 offset:20992
    s_waitcnt lgkmcnt(10)
    v_mfma_f32_32x32x16_bf16 v[176:191], v[52:55], v[116:119], v[176:191]
    ds_read_b64_tr_b16 v[52:53], v22 offset:22528
    ds_read_b64_tr_b16 v[54:55], v22 offset:23040
    s_waitcnt lgkmcnt(10)
    v_mfma_f32_32x32x16_bf16 v[176:191], v[56:59], v[120:123], v[176:191]
    ds_read_b64_tr_b16 v[56:57], v22 offset:24576
    ds_read_b64_tr_b16 v[58:59], v22 offset:25088
    s_waitcnt lgkmcnt(10)
    v_mfma_f32_32x32x16_bf16 v[176:191], v[60:63], v[124:127], v[176:191]
    ds_read_b64_tr_b16 v[60:61], v22 offset:26624
    ds_read_b64_tr_b16 v[62:63], v22 offset:27136
    s_waitcnt lgkmcnt(10)
    v_mfma_f32_32x32x16_bf16 v[192:207], v[40:43], v[64:67], 0
    ds_read_b64_tr_b16 v[40:41], v22 offset:28672
    ds_read_b64_tr_b16 v[42:43], v22 offset:29184
    s_waitcnt lgkmcnt(10)
    v_mfma_f32_32x32x16_bf16 v[192:207], v[44:47], v[68:71], v[192:207]
    ds_read_b64_tr_b16 v[44:45], v22 offset:30720
    ds_read_b64_tr_b16 v[46:47], v22 offset:31232
    s_waitcnt lgkmcnt(10)
    v_mfma_f32_32x32x16_bf16 v[192:207], v[48:51], v[72:75], v[192:207]
    v_cvt_pk_bf16_f32 v176, v176, v177
    v_cvt_pk_bf16_f32 v177, v178, v179
    v_cvt_pk_bf16_f32 v178, v180, v181
    v_cvt_pk_bf16_f32 v179, v182, v183
    s_add_u32 s3, s97, 3
    s_sub_u32 s48, s3, 7
    s_cmp_ge_u32 s3, 7
    s_cselect_b32 s3, s48, s3
    s_lshl_b32 s3, s3, 11
    buffer_store_dwordx4 v[176:179], v30, s[24:27], s3 offen offset:0
    s_mov_b32 s3, 4294901760
    v_add_u32 v22, s3, v22
    ds_read_b64_tr_b16 v[48:49], v22 offset:0
    ds_read_b64_tr_b16 v[50:51], v22 offset:512
    s_waitcnt lgkmcnt(10)
    v_mfma_f32_32x32x16_bf16 v[192:207], v[52:55], v[76:79], v[192:207]
    v_cvt_pk_bf16_f32 v184, v184, v185
    v_cvt_pk_bf16_f32 v185, v186, v187
    v_cvt_pk_bf16_f32 v186, v188, v189
    v_cvt_pk_bf16_f32 v187, v190, v191
    s_add_u32 s3, s97, 3
    s_sub_u32 s48, s3, 7
    s_cmp_ge_u32 s3, 7
    s_cselect_b32 s3, s48, s3
    s_lshl_b32 s3, s3, 11
    buffer_store_dwordx4 v[184:187], v30, s[24:27], s3 offen offset:1024
    ds_read_b64_tr_b16 v[52:53], v22 offset:2048
    ds_read_b64_tr_b16 v[54:55], v22 offset:2560
    s_waitcnt lgkmcnt(10)
    v_mfma_f32_32x32x16_bf16 v[192:207], v[56:59], v[80:83], v[192:207]
    ds_read_b64_tr_b16 v[56:57], v22 offset:4096
    ds_read_b64_tr_b16 v[58:59], v22 offset:4608
    s_waitcnt lgkmcnt(10)
    v_mfma_f32_32x32x16_bf16 v[192:207], v[60:63], v[84:87], v[192:207]
    ds_read_b64_tr_b16 v[60:61], v22 offset:6144
    ds_read_b64_tr_b16 v[62:63], v22 offset:6656
    s_waitcnt lgkmcnt(10)
    v_mfma_f32_32x32x16_bf16 v[192:207], v[40:43], v[88:91], v[192:207]
    ds_read_b64_tr_b16 v[40:41], v22 offset:8192
    ds_read_b64_tr_b16 v[42:43], v22 offset:8704
    s_waitcnt lgkmcnt(10)
    v_mfma_f32_32x32x16_bf16 v[192:207], v[44:47], v[92:95], v[192:207]
    ds_read_b64_tr_b16 v[44:45], v22 offset:10240
    ds_read_b64_tr_b16 v[46:47], v22 offset:10752
    s_waitcnt lgkmcnt(10)
    v_mfma_f32_32x32x16_bf16 v[192:207], v[48:51], v[96:99], v[192:207]
    ds_read_b64_tr_b16 v[48:49], v22 offset:12288
    ds_read_b64_tr_b16 v[50:51], v22 offset:12800
    s_waitcnt lgkmcnt(10)
    v_mfma_f32_32x32x16_bf16 v[192:207], v[52:55], v[100:103], v[192:207]
    ds_read_b64_tr_b16 v[52:53], v22 offset:14336
    ds_read_b64_tr_b16 v[54:55], v22 offset:14848
    s_waitcnt lgkmcnt(10)
    v_mfma_f32_32x32x16_bf16 v[192:207], v[56:59], v[104:107], v[192:207]
    s_barrier
    ds_read_b64_tr_b16 v[56:57], v22 offset:16384
    ds_read_b64_tr_b16 v[58:59], v22 offset:16896
    s_waitcnt lgkmcnt(10)
    v_mfma_f32_32x32x16_bf16 v[192:207], v[60:63], v[108:111], v[192:207]
    ds_read_b64_tr_b16 v[60:61], v22 offset:18432
    ds_read_b64_tr_b16 v[62:63], v22 offset:18944
    s_waitcnt lgkmcnt(10)
    v_mfma_f32_32x32x16_bf16 v[192:207], v[40:43], v[112:115], v[192:207]
    ds_read_b64_tr_b16 v[40:41], v22 offset:20480
    ds_read_b64_tr_b16 v[42:43], v22 offset:20992
    s_waitcnt lgkmcnt(10)
    v_mfma_f32_32x32x16_bf16 v[192:207], v[44:47], v[116:119], v[192:207]
    ds_read_b64_tr_b16 v[44:45], v22 offset:22528
    ds_read_b64_tr_b16 v[46:47], v22 offset:23040
    s_waitcnt lgkmcnt(10)
    v_mfma_f32_32x32x16_bf16 v[192:207], v[48:51], v[120:123], v[192:207]
    ds_read_b64_tr_b16 v[48:49], v22 offset:24576
    ds_read_b64_tr_b16 v[50:51], v22 offset:25088
    s_waitcnt lgkmcnt(10)
    v_mfma_f32_32x32x16_bf16 v[192:207], v[52:55], v[124:127], v[192:207]
    ds_read_b64_tr_b16 v[52:53], v22 offset:26624
    ds_read_b64_tr_b16 v[54:55], v22 offset:27136
    s_waitcnt lgkmcnt(10)
    v_mfma_f32_32x32x16_bf16 v[208:223], v[56:59], v[64:67], 0
    ds_read_b64_tr_b16 v[56:57], v22 offset:28672
    ds_read_b64_tr_b16 v[58:59], v22 offset:29184
    s_waitcnt lgkmcnt(10)
    v_mfma_f32_32x32x16_bf16 v[208:223], v[60:63], v[68:71], v[208:223]
    ds_read_b64_tr_b16 v[60:61], v22 offset:30720
    ds_read_b64_tr_b16 v[62:63], v22 offset:31232
    s_waitcnt lgkmcnt(10)
    v_mfma_f32_32x32x16_bf16 v[208:223], v[40:43], v[72:75], v[208:223]
    v_cvt_pk_bf16_f32 v192, v192, v193
    v_cvt_pk_bf16_f32 v193, v194, v195
    v_cvt_pk_bf16_f32 v194, v196, v197
    v_cvt_pk_bf16_f32 v195, v198, v199
    s_add_u32 s3, s97, 4
    s_sub_u32 s48, s3, 7
    s_cmp_ge_u32 s3, 7
    s_cselect_b32 s3, s48, s3
    s_lshl_b32 s3, s3, 11
    buffer_store_dwordx4 v[192:195], v30, s[24:27], s3 offen offset:0
    ds_read_b64_tr_b16 v[40:41], v22 offset:32768
    ds_read_b64_tr_b16 v[42:43], v22 offset:33280
    s_waitcnt lgkmcnt(10)
    v_mfma_f32_32x32x16_bf16 v[208:223], v[44:47], v[76:79], v[208:223]
    v_cvt_pk_bf16_f32 v200, v200, v201
    v_cvt_pk_bf16_f32 v201, v202, v203
    v_cvt_pk_bf16_f32 v202, v204, v205
    v_cvt_pk_bf16_f32 v203, v206, v207
    s_add_u32 s3, s97, 4
    s_sub_u32 s48, s3, 7
    s_cmp_ge_u32 s3, 7
    s_cselect_b32 s3, s48, s3
    s_lshl_b32 s3, s3, 11
    buffer_store_dwordx4 v[200:203], v30, s[24:27], s3 offen offset:1024
    ds_read_b64_tr_b16 v[44:45], v22 offset:34816
    ds_read_b64_tr_b16 v[46:47], v22 offset:35328
    s_waitcnt lgkmcnt(10)
    v_mfma_f32_32x32x16_bf16 v[208:223], v[48:51], v[80:83], v[208:223]
    ds_read_b64_tr_b16 v[48:49], v22 offset:36864
    ds_read_b64_tr_b16 v[50:51], v22 offset:37376
    s_waitcnt lgkmcnt(10)
    v_mfma_f32_32x32x16_bf16 v[208:223], v[52:55], v[84:87], v[208:223]
    ds_read_b64_tr_b16 v[52:53], v22 offset:38912
    ds_read_b64_tr_b16 v[54:55], v22 offset:39424
    s_waitcnt lgkmcnt(10)
    v_mfma_f32_32x32x16_bf16 v[208:223], v[56:59], v[88:91], v[208:223]
    ds_read_b64_tr_b16 v[56:57], v22 offset:40960
    ds_read_b64_tr_b16 v[58:59], v22 offset:41472
    s_waitcnt lgkmcnt(10)
    v_mfma_f32_32x32x16_bf16 v[208:223], v[60:63], v[92:95], v[208:223]
    ds_read_b64_tr_b16 v[60:61], v22 offset:43008
    ds_read_b64_tr_b16 v[62:63], v22 offset:43520
    s_waitcnt lgkmcnt(10)
    v_mfma_f32_32x32x16_bf16 v[208:223], v[40:43], v[96:99], v[208:223]
    ds_read_b64_tr_b16 v[40:41], v22 offset:45056
    ds_read_b64_tr_b16 v[42:43], v22 offset:45568
    s_waitcnt lgkmcnt(10)
    v_mfma_f32_32x32x16_bf16 v[208:223], v[44:47], v[100:103], v[208:223]
    ds_read_b64_tr_b16 v[44:45], v22 offset:47104
    ds_read_b64_tr_b16 v[46:47], v22 offset:47616
    s_waitcnt lgkmcnt(10)
    v_mfma_f32_32x32x16_bf16 v[208:223], v[48:51], v[104:107], v[208:223]
    s_barrier
    s_mov_b32 s3, 49152
    v_add_u32 v22, s3, v22
    ds_read_b64_tr_b16 v[48:49], v22 offset:0
    ds_read_b64_tr_b16 v[50:51], v22 offset:512
    s_waitcnt lgkmcnt(10)
    v_mfma_f32_32x32x16_bf16 v[208:223], v[52:55], v[108:111], v[208:223]
    ds_read_b64_tr_b16 v[52:53], v22 offset:2048
    ds_read_b64_tr_b16 v[54:55], v22 offset:2560
    s_waitcnt lgkmcnt(10)
    v_mfma_f32_32x32x16_bf16 v[208:223], v[56:59], v[112:115], v[208:223]
    ds_read_b64_tr_b16 v[56:57], v22 offset:4096
    ds_read_b64_tr_b16 v[58:59], v22 offset:4608
    s_waitcnt lgkmcnt(10)
    v_mfma_f32_32x32x16_bf16 v[208:223], v[60:63], v[116:119], v[208:223]
    ds_read_b64_tr_b16 v[60:61], v22 offset:6144
    ds_read_b64_tr_b16 v[62:63], v22 offset:6656
    s_waitcnt lgkmcnt(10)
    v_mfma_f32_32x32x16_bf16 v[208:223], v[40:43], v[120:123], v[208:223]
    ds_read_b64_tr_b16 v[40:41], v22 offset:8192
    ds_read_b64_tr_b16 v[42:43], v22 offset:8704
    s_waitcnt lgkmcnt(10)
    v_mfma_f32_32x32x16_bf16 v[208:223], v[44:47], v[124:127], v[208:223]
    ds_read_b64_tr_b16 v[44:45], v22 offset:10240
    ds_read_b64_tr_b16 v[46:47], v22 offset:10752
    s_waitcnt lgkmcnt(10)
    v_mfma_f32_32x32x16_bf16 v[224:239], v[48:51], v[64:67], 0
    ds_read_b64_tr_b16 v[48:49], v22 offset:12288
    ds_read_b64_tr_b16 v[50:51], v22 offset:12800
    s_waitcnt lgkmcnt(10)
    v_mfma_f32_32x32x16_bf16 v[224:239], v[52:55], v[68:71], v[224:239]
    ds_read_b64_tr_b16 v[52:53], v22 offset:14336
    ds_read_b64_tr_b16 v[54:55], v22 offset:14848
    s_waitcnt lgkmcnt(10)
    v_mfma_f32_32x32x16_bf16 v[224:239], v[56:59], v[72:75], v[224:239]
    v_cvt_pk_bf16_f32 v208, v208, v209
    v_cvt_pk_bf16_f32 v209, v210, v211
    v_cvt_pk_bf16_f32 v210, v212, v213
    v_cvt_pk_bf16_f32 v211, v214, v215
    s_add_u32 s3, s97, 5
    s_sub_u32 s48, s3, 7
    s_cmp_ge_u32 s3, 7
    s_cselect_b32 s3, s48, s3
    s_lshl_b32 s3, s3, 11
    buffer_store_dwordx4 v[208:211], v30, s[24:27], s3 offen offset:0
    s_mov_b32 s3, 4294852608
    v_add_u32 v22, s3, v22
    ds_read_b64_tr_b16 v[56:57], v22 offset:0
    ds_read_b64_tr_b16 v[58:59], v22 offset:512
    s_waitcnt lgkmcnt(10)
    v_mfma_f32_32x32x16_bf16 v[224:239], v[60:63], v[76:79], v[224:239]
    v_cvt_pk_bf16_f32 v216, v216, v217
    v_cvt_pk_bf16_f32 v217, v218, v219
    v_cvt_pk_bf16_f32 v218, v220, v221
    v_cvt_pk_bf16_f32 v219, v222, v223
    s_add_u32 s3, s97, 5
    s_sub_u32 s48, s3, 7
    s_cmp_ge_u32 s3, 7
    s_cselect_b32 s3, s48, s3
    s_lshl_b32 s3, s3, 11
    buffer_store_dwordx4 v[216:219], v30, s[24:27], s3 offen offset:1024
    ds_read_b64_tr_b16 v[60:61], v22 offset:2048
    ds_read_b64_tr_b16 v[62:63], v22 offset:2560
    s_waitcnt lgkmcnt(10)
    v_mfma_f32_32x32x16_bf16 v[224:239], v[40:43], v[80:83], v[224:239]
    ds_read_b64_tr_b16 v[40:41], v22 offset:4096
    ds_read_b64_tr_b16 v[42:43], v22 offset:4608
    s_waitcnt lgkmcnt(10)
    v_mfma_f32_32x32x16_bf16 v[224:239], v[44:47], v[84:87], v[224:239]
    ds_read_b64_tr_b16 v[44:45], v22 offset:6144
    ds_read_b64_tr_b16 v[46:47], v22 offset:6656
    s_waitcnt lgkmcnt(10)
    v_mfma_f32_32x32x16_bf16 v[224:239], v[48:51], v[88:91], v[224:239]
    ds_read_b64_tr_b16 v[48:49], v22 offset:8192
    ds_read_b64_tr_b16 v[50:51], v22 offset:8704
    s_waitcnt lgkmcnt(10)
    v_mfma_f32_32x32x16_bf16 v[224:239], v[52:55], v[92:95], v[224:239]
    ds_read_b64_tr_b16 v[52:53], v22 offset:10240
    ds_read_b64_tr_b16 v[54:55], v22 offset:10752
    s_waitcnt lgkmcnt(10)
    v_mfma_f32_32x32x16_bf16 v[224:239], v[56:59], v[96:99], v[224:239]
    ds_read_b64_tr_b16 v[56:57], v22 offset:12288
    ds_read_b64_tr_b16 v[58:59], v22 offset:12800
    s_waitcnt lgkmcnt(10)
    v_mfma_f32_32x32x16_bf16 v[224:239], v[60:63], v[100:103], v[224:239]
    ds_read_b64_tr_b16 v[60:61], v22 offset:14336
    ds_read_b64_tr_b16 v[62:63], v22 offset:14848
    s_waitcnt lgkmcnt(10)
    v_mfma_f32_32x32x16_bf16 v[224:239], v[40:43], v[104:107], v[224:239]
    s_waitcnt lgkmcnt(8)
    v_mfma_f32_32x32x16_bf16 v[224:239], v[44:47], v[108:111], v[224:239]
    s_waitcnt lgkmcnt(6)
    v_mfma_f32_32x32x16_bf16 v[224:239], v[48:51], v[112:115], v[224:239]
    s_waitcnt lgkmcnt(4)
    v_mfma_f32_32x32x16_bf16 v[224:239], v[52:55], v[116:119], v[224:239]
    s_waitcnt lgkmcnt(2)
    v_mfma_f32_32x32x16_bf16 v[224:239], v[56:59], v[120:123], v[224:239]
    s_waitcnt lgkmcnt(0)
    v_mfma_f32_32x32x16_bf16 v[224:239], v[60:63], v[124:127], v[224:239]
    s_nop 15
    s_nop 3
    v_cvt_pk_bf16_f32 v224, v224, v225
    v_cvt_pk_bf16_f32 v225, v226, v227
    v_cvt_pk_bf16_f32 v226, v228, v229
    v_cvt_pk_bf16_f32 v227, v230, v231
    s_add_u32 s3, s97, 6
    s_sub_u32 s48, s3, 7
    s_cmp_ge_u32 s3, 7
    s_cselect_b32 s3, s48, s3
    s_lshl_b32 s3, s3, 11
    buffer_store_dwordx4 v[224:227], v30, s[24:27], s3 offen offset:0
    v_cvt_pk_bf16_f32 v232, v232, v233
    v_cvt_pk_bf16_f32 v233, v234, v235
    v_cvt_pk_bf16_f32 v234, v236, v237
    v_cvt_pk_bf16_f32 v235, v238, v239
    s_add_u32 s3, s97, 6
    s_sub_u32 s48, s3, 7
    s_cmp_ge_u32 s3, 7
    s_cselect_b32 s3, s48, s3
    s_lshl_b32 s3, s3, 11
    buffer_store_dwordx4 v[232:235], v30, s[24:27], s3 offen offset:1024
attn_end:
    s_endpgm
attn_loader:
    s_lshl_b32 s3, s32, 1
    s_add_u32 s3, s3, s33
    s_mul_i32 s3, s3, 57344
    s_add_u32 s4, s36, s3
    s_addc_u32 s5, s37, 0
    s_and_b32 s5, s5, 0xffff
    s_mov_b32 s6, 57344
    s_mov_b32 s7, 0x20000
    s_mov_b32 s16, s42
    s_and_b32 s17, s43, 0xffff
    s_mov_b32 s18, 3670016
    s_mov_b32 s19, 0x20000
    s_lshl_b32 s3, s32, 4
    s_add_u32 s3, s3, s31
    s_lshl_b32 s3, s3, 18
    s_add_u32 s8, s38, s3
    s_addc_u32 s9, s39, 0
    s_and_b32 s9, s9, 0xffff
    s_mov_b32 s10, 262144
    s_mov_b32 s11, 0x20000
    s_add_u32 s12, s40, s3
    s_addc_u32 s13, s41, 0
    s_and_b32 s13, s13, 0xffff
    s_mov_b32 s14, 262144
    s_mov_b32 s15, 0x20000
    s_mul_i32 s3, s31, 229376
    s_add_u32 s20, s44, s3
    s_addc_u32 s21, s45, 0
    s_and_b32 s21, s21, 0xffff
    s_mov_b32 s22, 229376
    s_mov_b32 s23, 0x20000
    s_lshl_b32 s51, s31, 9
    s_lshl_b32 s3, s28, 14
    s_add_u32 s51, s51, s3
    s_mul_i32 s36, s28, 896
    v_lshrrev_b32 v16, 5, v1
    v_and_b32 v17, 31, v1
    v_mov_b32 v20, 0x40000000
    s_add_u32 s3, s28, 0
    v_xor_b32 v18, s3, v1
    v_lshlrev_b32 v19, 4, v18
    v_cmp_gt_u32 vcc, 56, v18
    s_nop 1
    v_cndmask_b32 v8, v20, v19, vcc
    s_add_u32 s3, s28, 4
    v_xor_b32 v18, s3, v1
    v_lshlrev_b32 v19, 4, v18
    v_cmp_gt_u32 vcc, 56, v18
    s_nop 1
    v_cndmask_b32 v9, v20, v19, vcc
    s_add_u32 s3, s28, 8
    v_xor_b32 v18, s3, v1
    v_lshlrev_b32 v19, 4, v18
    v_cmp_gt_u32 vcc, 56, v18
    s_nop 1
    v_cndmask_b32 v10, v20, v19, vcc
    s_add_u32 s3, s28, 12
    v_xor_b32 v18, s3, v1
    v_lshlrev_b32 v19, 4, v18
    v_cmp_gt_u32 vcc, 56, v18
    s_nop 1
    v_cndmask_b32 v11, v20, v19, vcc
    s_lshl_b32 s3, s35, 1
    v_add_u32 v18, s3, v16
    v_lshlrev_b32 v18, 2, v18
    v_xor_b32 v18, v17, v18
    v_lshlrev_b32 v18, 4, v18
    v_lshl_add_u32 v4, v16, 9, v18
    v_lshl_add_u32 v5, v16, 13, v18
    v_xor_b32 v18, v17, v16
    v_lshlrev_b32 v18, 4, v18
    v_lshl_add_u32 v19, v16, 9, v18
    s_lshl_b32 s3, s28, 5
    v_xor_b32 v2, s3, v19
    v_xor_b32 v3, 0x80, v2
    v_lshrrev_b32 v18, 3, v1
    v_mul_u32_u24 v18, 896, v18
    v_lshrrev_b32 v19, 2, v1
    v_lshrrev_b32 v21, 4, v1
    v_xor_b32 v19, v19, v21
    v_and_b32 v19, 1, v19
    v_lshl_add_u32 v18, v19, 6, v18
    v_and_b32 v19, 3, v1
    v_lshl_add_u32 v6, v19, 4, v18
    s_mul_i32 s37, s28, 7168
    s_add_u32 m0, s34, 8192
    s_add_u32 s3, s36, 7168
    buffer_load_dwordx4 v10, s[4:7], s3 offen lds
    s_add_u32 m0, s34, 12288
    s_add_u32 s3, s36, 10752
    buffer_load_dwordx4 v11, s[4:7], s3 offen lds
    s_add_u32 m0, s34, 24576
    s_add_u32 s3, s36, 21504
    buffer_load_dwordx4 v10, s[4:7], s3 offen lds
    s_add_u32 m0, s34, 28672
    s_add_u32 s3, s36, 25088
    buffer_load_dwordx4 v11, s[4:7], s3 offen lds
    s_add_u32 m0, s34, 40960
    s_add_u32 s3, s36, 35840
    buffer_load_dwordx4 v10, s[4:7], s3 offen lds
    s_add_u32 m0, s34, 45056
    s_add_u32 s3, s36, 39424
    buffer_load_dwordx4 v11, s[4:7], s3 offen lds
    s_add_u32 m0, s34, 57344
    s_add_u32 s3, s36, 50176
    buffer_load_dwordx4 v10, s[4:7], s3 offen lds
    s_add_u32 m0, s34, 61440
    s_add_u32 s3, s36, 53760
    buffer_load_dwordx4 v11, s[4:7], s3 offen lds
    s_add_u32 m0, s34, 65536
    s_add_u32 s39, s98, 0
    s_sub_u32 s40, s39, 14
    s_cmp_ge_u32 s39, 14
    s_cselect_b32 s39, s40, s39
    s_lshl_b32 s39, s39, 18
    s_add_u32 s38, s39, s51
    s_add_u32 m0, s34, 65536
    s_add_u32 s3, s38, 0
    buffer_load_dwordx4 v5, s[16:19], s3 offen lds
    s_add_u32 m0, s34, 69632
    s_add_u32 s3, s38, 65536
    buffer_load_dwordx4 v5, s[16:19], s3 offen lds
    s_add_u32 m0, s34, 73728
    s_add_u32 s3, s38, 131072
    buffer_load_dwordx4 v5, s[16:19], s3 offen lds
    s_add_u32 m0, s34, 77824
    s_add_u32 s3, s38, 196608
    buffer_load_dwordx4 v5, s[16:19], s3 offen lds
    s_add_u32 m0, s34, 81920
    s_add_u32 s39, s98, 1
    s_sub_u32 s40, s39, 14
    s_cmp_ge_u32 s39, 14
    s_cselect_b32 s39, s40, s39
    s_lshl_b32 s39, s39, 18
    s_add_u32 s38, s39, s51
    s_add_u32 m0, s34, 81920
    s_add_u32 s3, s38, 0
    buffer_load_dwordx4 v5, s[16:19], s3 offen lds
    s_add_u32 m0, s34, 86016
    s_add_u32 s3, s38, 65536
    buffer_load_dwordx4 v5, s[16:19], s3 offen lds
    s_add_u32 m0, s34, 90112
    s_add_u32 s3, s38, 131072
    buffer_load_dwordx4 v5, s[16:19], s3 offen lds
    s_add_u32 m0, s34, 94208
    s_add_u32 s3, s38, 196608
    buffer_load_dwordx4 v5, s[16:19], s3 offen lds
    s_waitcnt vmcnt(8)
    s_barrier
    s_add_u32 m0, s34, 98304
    s_add_u32 s39, s98, 2
    s_sub_u32 s40, s39, 14
    s_cmp_ge_u32 s39, 14
    s_cselect_b32 s39, s40, s39
    s_lshl_b32 s39, s39, 18
    s_add_u32 s38, s39, s51
    s_add_u32 m0, s34, 98304
    s_add_u32 s3, s38, 0
    buffer_load_dwordx4 v5, s[16:19], s3 offen lds
    s_add_u32 m0, s34, 102400
    s_add_u32 s3, s38, 65536
    buffer_load_dwordx4 v5, s[16:19], s3 offen lds
    s_add_u32 m0, s34, 106496
    s_add_u32 s3, s38, 131072
    buffer_load_dwordx4 v5, s[16:19], s3 offen lds
    s_add_u32 m0, s34, 110592
    s_add_u32 s3, s38, 196608
    buffer_load_dwordx4 v5, s[16:19], s3 offen lds
    s_add_u32 m0, s34, 114688
    s_add_u32 s39, s98, 3
    s_sub_u32 s40, s39, 14
    s_cmp_ge_u32 s39, 14
    s_cselect_b32 s39, s40, s39
    s_lshl_b32 s39, s39, 18
    s_add_u32 s38, s39, s51
    s_add_u32 m0, s34, 114688
    s_add_u32 s3, s38, 0
    buffer_load_dwordx4 v5, s[16:19], s3 offen lds
    s_add_u32 m0, s34, 118784
    s_add_u32 s3, s38, 65536
    buffer_load_dwordx4 v5, s[16:19], s3 offen lds
    s_add_u32 m0, s34, 122880
    s_add_u32 s3, s38, 131072
    buffer_load_dwordx4 v5, s[16:19], s3 offen lds
    s_add_u32 m0, s34, 126976
    s_add_u32 s3, s38, 196608
    buffer_load_dwordx4 v5, s[16:19], s3 offen lds
    s_waitcnt vmcnt(12)
    s_barrier
    s_add_u32 m0, s34, 131072
    s_add_u32 s3, s95, 0
    buffer_load_dwordx4 v2, s[8:11], s3 offen nt lds
    s_add_u32 m0, s34, 135168
    s_add_u32 s3, s95, 4096
    buffer_load_dwordx4 v3, s[8:11], s3 offen nt lds
    s_add_u32 m0, s34, 139264
    s_add_u32 s3, s95, 8192
    buffer_load_dwordx4 v2, s[8:11], s3 offen nt lds
    s_add_u32 m0, s34, 143360
    s_add_u32 s3, s95, 12288
    buffer_load_dwordx4 v3, s[8:11], s3 offen nt lds
    s_add_u32 m0, s34, 147456
    s_add_u32 s3, s95, 16384
    buffer_load_dwordx4 v2, s[8:11], s3 offen nt lds
    s_add_u32 m0, s34, 151552
    s_add_u32 s3, s95, 20480
    buffer_load_dwordx4 v3, s[8:11], s3 offen nt lds
    s_add_u32 m0, s34, 155648
    s_add_u32 s3, s95, 24576
    buffer_load_dwordx4 v2, s[8:11], s3 offen nt lds
    s_add_u32 m0, s34, 159744
    s_add_u32 s3, s95, 28672
    buffer_load_dwordx4 v3, s[8:11], s3 offen nt lds
    s_waitcnt vmcnt(16)
    s_barrier
    s_add_u32 m0, s34, 0
    s_add_u32 s39, s98, 4
    s_sub_u32 s40, s39, 14
    s_cmp_ge_u32 s39, 14
    s_cselect_b32 s39, s40, s39
    s_lshl_b32 s39, s39, 18
    s_add_u32 s38, s39, s51
    s_add_u32 m0, s34, 0
    s_add_u32 s3, s38, 0
    buffer_load_dwordx4 v5, s[16:19], s3 offen lds
    s_add_u32 m0, s34, 4096
    s_add_u32 s3, s38, 65536
    buffer_load_dwordx4 v5, s[16:19], s3 offen lds
    s_add_u32 m0, s34, 8192
    s_add_u32 s3, s38, 131072
    buffer_load_dwordx4 v5, s[16:19], s3 offen lds
    s_add_u32 m0, s34, 12288
    s_add_u32 s3, s38, 196608
    buffer_load_dwordx4 v5, s[16:19], s3 offen lds
    s_add_u32 m0, s34, 16384
    s_add_u32 s39, s98, 5
    s_sub_u32 s40, s39, 14
    s_cmp_ge_u32 s39, 14
    s_cselect_b32 s39, s40, s39
    s_lshl_b32 s39, s39, 18
    s_add_u32 s38, s39, s51
    s_add_u32 m0, s34, 16384
    s_add_u32 s3, s38, 0
    buffer_load_dwordx4 v5, s[16:19], s3 offen lds
    s_add_u32 m0, s34, 20480
    s_add_u32 s3, s38, 65536
    buffer_load_dwordx4 v5, s[16:19], s3 offen lds
    s_add_u32 m0, s34, 24576
    s_add_u32 s3, s38, 131072
    buffer_load_dwordx4 v5, s[16:19], s3 offen lds
    s_add_u32 m0, s34, 28672
    s_add_u32 s3, s38, 196608
    buffer_load_dwordx4 v5, s[16:19], s3 offen lds
    s_waitcnt vmcnt(20)
    s_barrier
    s_add_u32 m0, s34, 32768
    s_add_u32 s39, s98, 6
    s_sub_u32 s40, s39, 14
    s_cmp_ge_u32 s39, 14
    s_cselect_b32 s39, s40, s39
    s_lshl_b32 s39, s39, 18
    s_add_u32 s38, s39, s51
    s_add_u32 m0, s34, 32768
    s_add_u32 s3, s38, 0
    buffer_load_dwordx4 v5, s[16:19], s3 offen lds
    s_add_u32 m0, s34, 36864
    s_add_u32 s3, s38, 65536
    buffer_load_dwordx4 v5, s[16:19], s3 offen lds
    s_add_u32 m0, s34, 40960
    s_add_u32 s3, s38, 131072
    buffer_load_dwordx4 v5, s[16:19], s3 offen lds
    s_add_u32 m0, s34, 45056
    s_add_u32 s3, s38, 196608
    buffer_load_dwordx4 v5, s[16:19], s3 offen lds
    s_add_u32 m0, s34, 49152
    s_add_u32 s39, s98, 7
    s_sub_u32 s40, s39, 14
    s_cmp_ge_u32 s39, 14
    s_cselect_b32 s39, s40, s39
    s_lshl_b32 s39, s39, 18
    s_add_u32 s38, s39, s51
    s_add_u32 m0, s34, 49152
    s_add_u32 s3, s38, 0
    buffer_load_dwordx4 v5, s[16:19], s3 offen lds
    s_add_u32 m0, s34, 53248
    s_add_u32 s3, s38, 65536
    buffer_load_dwordx4 v5, s[16:19], s3 offen lds
    s_add_u32 m0, s34, 57344
    s_add_u32 s3, s38, 131072
    buffer_load_dwordx4 v5, s[16:19], s3 offen lds
    s_add_u32 m0, s34, 61440
    s_add_u32 s3, s38, 196608
    buffer_load_dwordx4 v5, s[16:19], s3 offen lds
    s_waitcnt vmcnt(24)
    s_barrier
    s_add_u32 m0, s34, 65536
    s_add_u32 s39, s98, 8
    s_sub_u32 s40, s39, 14
    s_cmp_ge_u32 s39, 14
    s_cselect_b32 s39, s40, s39
    s_lshl_b32 s39, s39, 18
    s_add_u32 s38, s39, s51
    s_add_u32 m0, s34, 65536
    s_add_u32 s3, s38, 0
    buffer_load_dwordx4 v5, s[16:19], s3 offen lds
    s_add_u32 m0, s34, 69632
    s_add_u32 s3, s38, 65536
    buffer_load_dwordx4 v5, s[16:19], s3 offen lds
    s_add_u32 m0, s34, 73728
    s_add_u32 s3, s38, 131072
    buffer_load_dwordx4 v5, s[16:19], s3 offen lds
    s_add_u32 m0, s34, 77824
    s_add_u32 s3, s38, 196608
    buffer_load_dwordx4 v5, s[16:19], s3 offen lds
    s_add_u32 m0, s34, 81920
    s_add_u32 s39, s98, 9
    s_sub_u32 s40, s39, 14
    s_cmp_ge_u32 s39, 14
    s_cselect_b32 s39, s40, s39
    s_lshl_b32 s39, s39, 18
    s_add_u32 s38, s39, s51
    s_add_u32 m0, s34, 81920
    s_add_u32 s3, s38, 0
    buffer_load_dwordx4 v5, s[16:19], s3 offen lds
    s_add_u32 m0, s34, 86016
    s_add_u32 s3, s38, 65536
    buffer_load_dwordx4 v5, s[16:19], s3 offen lds
    s_add_u32 m0, s34, 90112
    s_add_u32 s3, s38, 131072
    buffer_load_dwordx4 v5, s[16:19], s3 offen lds
    s_add_u32 m0, s34, 94208
    s_add_u32 s3, s38, 196608
    buffer_load_dwordx4 v5, s[16:19], s3 offen lds
    s_waitcnt vmcnt(20)
    s_barrier
    s_add_u32 m0, s34, 98304
    s_add_u32 s39, s98, 10
    s_sub_u32 s40, s39, 14
    s_cmp_ge_u32 s39, 14
    s_cselect_b32 s39, s40, s39
    s_lshl_b32 s39, s39, 18
    s_add_u32 s38, s39, s51
    s_add_u32 m0, s34, 98304
    s_add_u32 s3, s38, 0
    buffer_load_dwordx4 v5, s[16:19], s3 offen lds
    s_add_u32 m0, s34, 102400
    s_add_u32 s3, s38, 65536
    buffer_load_dwordx4 v5, s[16:19], s3 offen lds
    s_add_u32 m0, s34, 106496
    s_add_u32 s3, s38, 131072
    buffer_load_dwordx4 v5, s[16:19], s3 offen lds
    s_add_u32 m0, s34, 110592
    s_add_u32 s3, s38, 196608
    buffer_load_dwordx4 v5, s[16:19], s3 offen lds
    s_waitcnt vmcnt(20)
    s_barrier
    s_add_u32 m0, s34, 114688
    s_add_u32 s39, s98, 11
    s_sub_u32 s40, s39, 14
    s_cmp_ge_u32 s39, 14
    s_cselect_b32 s39, s40, s39
    s_lshl_b32 s39, s39, 18
    s_add_u32 s38, s39, s51
    s_add_u32 m0, s34, 114688
    s_add_u32 s3, s38, 0
    buffer_load_dwordx4 v5, s[16:19], s3 offen lds
    s_add_u32 m0, s34, 118784
    s_add_u32 s3, s38, 65536
    buffer_load_dwordx4 v5, s[16:19], s3 offen lds
    s_add_u32 m0, s34, 122880
    s_add_u32 s3, s38, 131072
    buffer_load_dwordx4 v5, s[16:19], s3 offen lds
    s_add_u32 m0, s34, 126976
    s_add_u32 s3, s38, 196608
    buffer_load_dwordx4 v5, s[16:19], s3 offen lds
    s_waitcnt vmcnt(20)
    s_barrier
    s_add_u32 m0, s34, 0
    s_add_u32 s39, s98, 12
    s_sub_u32 s40, s39, 14
    s_cmp_ge_u32 s39, 14
    s_cselect_b32 s39, s40, s39
    s_lshl_b32 s39, s39, 18
    s_add_u32 s38, s39, s51
    s_add_u32 m0, s34, 0
    s_add_u32 s3, s38, 0
    buffer_load_dwordx4 v5, s[16:19], s3 offen lds
    s_add_u32 m0, s34, 4096
    s_add_u32 s3, s38, 65536
    buffer_load_dwordx4 v5, s[16:19], s3 offen lds
    s_add_u32 m0, s34, 8192
    s_add_u32 s3, s38, 131072
    buffer_load_dwordx4 v5, s[16:19], s3 offen lds
    s_add_u32 m0, s34, 12288
    s_add_u32 s3, s38, 196608
    buffer_load_dwordx4 v5, s[16:19], s3 offen lds
    s_waitcnt vmcnt(20)
    s_barrier
    s_add_u32 m0, s34, 16384
    s_add_u32 s39, s98, 13
    s_sub_u32 s40, s39, 14
    s_cmp_ge_u32 s39, 14
    s_cselect_b32 s39, s40, s39
    s_lshl_b32 s39, s39, 18
    s_add_u32 s38, s39, s51
    s_add_u32 m0, s34, 16384
    s_add_u32 s3, s38, 0
    buffer_load_dwordx4 v5, s[16:19], s3 offen lds
    s_add_u32 m0, s34, 20480
    s_add_u32 s3, s38, 65536
    buffer_load_dwordx4 v5, s[16:19], s3 offen lds
    s_add_u32 m0, s34, 24576
    s_add_u32 s3, s38, 131072
    buffer_load_dwordx4 v5, s[16:19], s3 offen lds
    s_add_u32 m0, s34, 28672
    s_add_u32 s3, s38, 196608
    buffer_load_dwordx4 v5, s[16:19], s3 offen lds
    s_waitcnt vmcnt(20)
    s_barrier
    s_waitcnt vmcnt(16)
    s_barrier
    s_waitcnt vmcnt(12)
    s_barrier
    s_add_u32 m0, s34, 65536
    s_add_u32 s3, s95, 32768
    buffer_load_dwordx4 v2, s[8:11], s3 offen nt lds
    s_add_u32 m0, s34, 69632
    s_add_u32 s3, s95, 36864
    buffer_load_dwordx4 v3, s[8:11], s3 offen nt lds
    s_add_u32 m0, s34, 73728
    s_add_u32 s3, s95, 40960
    buffer_load_dwordx4 v2, s[8:11], s3 offen nt lds
    s_add_u32 m0, s34, 77824
    s_add_u32 s3, s95, 45056
    buffer_load_dwordx4 v3, s[8:11], s3 offen nt lds
    s_waitcnt vmcnt(12)
    s_barrier
    s_add_u32 m0, s34, 81920
    s_add_u32 s3, s95, 49152
    buffer_load_dwordx4 v2, s[8:11], s3 offen nt lds
    s_add_u32 m0, s34, 86016
    s_add_u32 s3, s95, 53248
    buffer_load_dwordx4 v3, s[8:11], s3 offen nt lds
    s_add_u32 m0, s34, 90112
    s_add_u32 s3, s95, 57344
    buffer_load_dwordx4 v2, s[8:11], s3 offen nt lds
    s_add_u32 m0, s34, 94208
    s_add_u32 s3, s95, 61440
    buffer_load_dwordx4 v3, s[8:11], s3 offen nt lds
    s_waitcnt vmcnt(12)
    s_barrier
    s_add_u32 m0, s34, 98304
    s_add_u32 s3, s95, 65536
    buffer_load_dwordx4 v2, s[8:11], s3 offen nt lds
    s_add_u32 m0, s34, 102400
    s_add_u32 s3, s95, 69632
    buffer_load_dwordx4 v3, s[8:11], s3 offen nt lds
    s_add_u32 m0, s34, 106496
    s_add_u32 s3, s95, 73728
    buffer_load_dwordx4 v2, s[8:11], s3 offen nt lds
    s_add_u32 m0, s34, 110592
    s_add_u32 s3, s95, 77824
    buffer_load_dwordx4 v3, s[8:11], s3 offen nt lds
    s_waitcnt vmcnt(12)
    s_barrier
    s_add_u32 m0, s34, 114688
    s_add_u32 s3, s95, 81920
    buffer_load_dwordx4 v2, s[8:11], s3 offen nt lds
    s_add_u32 m0, s34, 118784
    s_add_u32 s3, s95, 86016
    buffer_load_dwordx4 v3, s[8:11], s3 offen nt lds
    s_add_u32 m0, s34, 122880
    s_add_u32 s3, s95, 90112
    buffer_load_dwordx4 v2, s[8:11], s3 offen nt lds
    s_add_u32 m0, s34, 126976
    s_add_u32 s3, s95, 94208
    buffer_load_dwordx4 v3, s[8:11], s3 offen nt lds
    s_barrier
    s_barrier
    s_add_u32 m0, s34, 0
    s_add_u32 s3, s95, 98304
    buffer_load_dwordx4 v2, s[8:11], s3 offen nt lds
    s_add_u32 m0, s34, 4096
    s_add_u32 s3, s95, 102400
    buffer_load_dwordx4 v3, s[8:11], s3 offen nt lds
    s_add_u32 m0, s34, 8192
    s_add_u32 s3, s95, 106496
    buffer_load_dwordx4 v2, s[8:11], s3 offen nt lds
    s_add_u32 m0, s34, 12288
    s_add_u32 s3, s95, 110592
    buffer_load_dwordx4 v3, s[8:11], s3 offen nt lds
    s_add_u32 m0, s34, 16384
    s_add_u32 s3, s95, 114688
    buffer_load_dwordx4 v2, s[8:11], s3 offen nt lds
    s_add_u32 m0, s34, 20480
    s_add_u32 s3, s95, 118784
    buffer_load_dwordx4 v3, s[8:11], s3 offen nt lds
    s_add_u32 m0, s34, 24576
    s_add_u32 s3, s95, 122880
    buffer_load_dwordx4 v2, s[8:11], s3 offen nt lds
    s_add_u32 m0, s34, 28672
    s_add_u32 s3, s95, 126976
    buffer_load_dwordx4 v3, s[8:11], s3 offen nt lds
    s_waitcnt vmcnt(16)
    s_barrier
    s_add_u32 m0, s34, 32768
    s_add_u32 s3, s96, 131072
    buffer_load_dwordx4 v2, s[8:11], s3 offen nt lds
    s_add_u32 m0, s34, 36864
    s_add_u32 s3, s96, 135168
    buffer_load_dwordx4 v3, s[8:11], s3 offen nt lds
    s_add_u32 m0, s34, 40960
    s_add_u32 s3, s96, 139264
    buffer_load_dwordx4 v2, s[8:11], s3 offen nt lds
    s_add_u32 m0, s34, 45056
    s_add_u32 s3, s96, 143360
    buffer_load_dwordx4 v3, s[8:11], s3 offen nt lds
    s_add_u32 m0, s34, 49152
    s_add_u32 s3, s96, 147456
    buffer_load_dwordx4 v2, s[8:11], s3 offen nt lds
    s_add_u32 m0, s34, 53248
    s_add_u32 s3, s96, 151552
    buffer_load_dwordx4 v3, s[8:11], s3 offen nt lds
    s_add_u32 m0, s34, 57344
    s_add_u32 s3, s96, 155648
    buffer_load_dwordx4 v2, s[8:11], s3 offen nt lds
    s_add_u32 m0, s34, 61440
    s_add_u32 s3, s96, 159744
    buffer_load_dwordx4 v3, s[8:11], s3 offen nt lds
    s_waitcnt vmcnt(16)
    s_barrier
    s_add_u32 m0, s34, 131072
    s_add_u32 s3, s96, 163840
    buffer_load_dwordx4 v2, s[8:11], s3 offen nt lds
    s_add_u32 m0, s34, 135168
    s_add_u32 s3, s96, 167936
    buffer_load_dwordx4 v3, s[8:11], s3 offen nt lds
    s_add_u32 m0, s34, 139264
    s_add_u32 s3, s96, 172032
    buffer_load_dwordx4 v2, s[8:11], s3 offen nt lds
    s_add_u32 m0, s34, 143360
    s_add_u32 s3, s96, 176128
    buffer_load_dwordx4 v3, s[8:11], s3 offen nt lds
    s_add_u32 m0, s34, 147456
    s_add_u32 s3, s96, 180224
    buffer_load_dwordx4 v2, s[8:11], s3 offen nt lds
    s_add_u32 m0, s34, 151552
    s_add_u32 s3, s96, 184320
    buffer_load_dwordx4 v3, s[8:11], s3 offen nt lds
    s_add_u32 m0, s34, 155648
    s_add_u32 s3, s96, 188416
    buffer_load_dwordx4 v2, s[8:11], s3 offen nt lds
    s_add_u32 m0, s34, 159744
    s_add_u32 s3, s96, 192512
    buffer_load_dwordx4 v3, s[8:11], s3 offen nt lds
    s_waitcnt vmcnt(16)
    s_barrier
    s_add_u32 m0, s34, 65536
    s_add_u32 s3, s96, 196608
    buffer_load_dwordx4 v2, s[8:11], s3 offen nt lds
    s_add_u32 m0, s34, 69632
    s_add_u32 s3, s96, 200704
    buffer_load_dwordx4 v3, s[8:11], s3 offen nt lds
    s_add_u32 m0, s34, 73728
    s_add_u32 s3, s96, 204800
    buffer_load_dwordx4 v2, s[8:11], s3 offen nt lds
    s_add_u32 m0, s34, 77824
    s_add_u32 s3, s96, 208896
    buffer_load_dwordx4 v3, s[8:11], s3 offen nt lds
    s_add_u32 m0, s34, 81920
    s_add_u32 s3, s96, 212992
    buffer_load_dwordx4 v2, s[8:11], s3 offen nt lds
    s_add_u32 m0, s34, 86016
    s_add_u32 s3, s96, 217088
    buffer_load_dwordx4 v3, s[8:11], s3 offen nt lds
    s_add_u32 m0, s34, 90112
    s_add_u32 s3, s96, 221184
    buffer_load_dwordx4 v2, s[8:11], s3 offen nt lds
    s_add_u32 m0, s34, 94208
    s_add_u32 s3, s96, 225280
    buffer_load_dwordx4 v3, s[8:11], s3 offen nt lds
    s_waitcnt vmcnt(16)
    s_barrier
    s_add_u32 m0, s34, 98304
    s_add_u32 s3, s96, 229376
    buffer_load_dwordx4 v2, s[8:11], s3 offen nt lds
    s_add_u32 m0, s34, 102400
    s_add_u32 s3, s96, 233472
    buffer_load_dwordx4 v3, s[8:11], s3 offen nt lds
    s_add_u32 m0, s34, 106496
    s_add_u32 s3, s96, 237568
    buffer_load_dwordx4 v2, s[8:11], s3 offen nt lds
    s_add_u32 m0, s34, 110592
    s_add_u32 s3, s96, 241664
    buffer_load_dwordx4 v3, s[8:11], s3 offen nt lds
    s_add_u32 m0, s34, 114688
    s_add_u32 s3, s96, 245760
    buffer_load_dwordx4 v2, s[8:11], s3 offen nt lds
    s_add_u32 m0, s34, 118784
    s_add_u32 s3, s96, 249856
    buffer_load_dwordx4 v3, s[8:11], s3 offen nt lds
    s_add_u32 m0, s34, 122880
    s_add_u32 s3, s96, 253952
    buffer_load_dwordx4 v2, s[8:11], s3 offen nt lds
    s_add_u32 m0, s34, 126976
    s_add_u32 s3, s96, 258048
    buffer_load_dwordx4 v3, s[8:11], s3 offen nt lds
    s_waitcnt vmcnt(16)
    s_barrier
    s_add_u32 m0, s34, 16384
    s_add_u32 s3, s95, 0
    buffer_load_dwordx4 v4, s[12:15], s3 offen nt lds
    s_add_u32 m0, s34, 20480
    s_add_u32 s3, s95, 4096
    buffer_load_dwordx4 v4, s[12:15], s3 offen nt lds
    s_add_u32 m0, s34, 24576
    s_add_u32 s3, s95, 8192
    buffer_load_dwordx4 v4, s[12:15], s3 offen nt lds
    s_add_u32 m0, s34, 28672
    s_add_u32 s3, s95, 12288
    buffer_load_dwordx4 v4, s[12:15], s3 offen nt lds
    s_waitcnt vmcnt(12)
    s_barrier
    s_add_u32 m0, s34, 32768
    s_add_u32 s3, s95, 16384
    buffer_load_dwordx4 v4, s[12:15], s3 offen nt lds
    s_add_u32 m0, s34, 36864
    s_add_u32 s3, s95, 20480
    buffer_load_dwordx4 v4, s[12:15], s3 offen nt lds
    s_add_u32 m0, s34, 40960
    s_add_u32 s3, s95, 24576
    buffer_load_dwordx4 v4, s[12:15], s3 offen nt lds
    s_add_u32 m0, s34, 45056
    s_add_u32 s3, s95, 28672
    buffer_load_dwordx4 v4, s[12:15], s3 offen nt lds
    s_add_u32 m0, s34, 49152
    s_add_u32 s3, s95, 32768
    buffer_load_dwordx4 v4, s[12:15], s3 offen nt lds
    s_add_u32 m0, s34, 53248
    s_add_u32 s3, s95, 36864
    buffer_load_dwordx4 v4, s[12:15], s3 offen nt lds
    s_add_u32 m0, s34, 57344
    s_add_u32 s3, s95, 40960
    buffer_load_dwordx4 v4, s[12:15], s3 offen nt lds
    s_add_u32 m0, s34, 61440
    s_add_u32 s3, s95, 45056
    buffer_load_dwordx4 v4, s[12:15], s3 offen nt lds
    s_waitcnt vmcnt(12)
    s_barrier
    s_add_u32 m0, s34, 131072
    s_add_u32 s3, s95, 49152
    buffer_load_dwordx4 v4, s[12:15], s3 offen nt lds
    s_add_u32 m0, s34, 135168
    s_add_u32 s3, s95, 53248
    buffer_load_dwordx4 v4, s[12:15], s3 offen nt lds
    s_add_u32 m0, s34, 139264
    s_add_u32 s3, s95, 57344
    buffer_load_dwordx4 v4, s[12:15], s3 offen nt lds
    s_add_u32 m0, s34, 143360
    s_add_u32 s3, s95, 61440
    buffer_load_dwordx4 v4, s[12:15], s3 offen nt lds
    s_add_u32 m0, s34, 147456
    s_add_u32 s3, s95, 65536
    buffer_load_dwordx4 v4, s[12:15], s3 offen nt lds
    s_add_u32 m0, s34, 151552
    s_add_u32 s3, s95, 69632
    buffer_load_dwordx4 v4, s[12:15], s3 offen nt lds
    s_add_u32 m0, s34, 155648
    s_add_u32 s3, s95, 73728
    buffer_load_dwordx4 v4, s[12:15], s3 offen nt lds
    s_add_u32 m0, s34, 159744
    s_add_u32 s3, s95, 77824
    buffer_load_dwordx4 v4, s[12:15], s3 offen nt lds
    s_barrier
    s_add_u32 m0, s34, 65536
    s_add_u32 s3, s95, 81920
    buffer_load_dwordx4 v4, s[12:15], s3 offen nt lds
    s_add_u32 m0, s34, 69632
    s_add_u32 s3, s95, 86016
    buffer_load_dwordx4 v4, s[12:15], s3 offen nt lds
    s_add_u32 m0, s34, 73728
    s_add_u32 s3, s95, 90112
    buffer_load_dwordx4 v4, s[12:15], s3 offen nt lds
    s_add_u32 m0, s34, 77824
    s_add_u32 s3, s95, 94208
    buffer_load_dwordx4 v4, s[12:15], s3 offen nt lds
    s_add_u32 m0, s34, 81920
    s_add_u32 s3, s95, 98304
    buffer_load_dwordx4 v4, s[12:15], s3 offen nt lds
    s_add_u32 m0, s34, 86016
    s_add_u32 s3, s95, 102400
    buffer_load_dwordx4 v4, s[12:15], s3 offen nt lds
    s_add_u32 m0, s34, 90112
    s_add_u32 s3, s95, 106496
    buffer_load_dwordx4 v4, s[12:15], s3 offen nt lds
    s_add_u32 m0, s34, 94208
    s_add_u32 s3, s95, 110592
    buffer_load_dwordx4 v4, s[12:15], s3 offen nt lds
    s_add_u32 m0, s34, 98304
    s_add_u32 s3, s95, 114688
    buffer_load_dwordx4 v4, s[12:15], s3 offen nt lds
    s_add_u32 m0, s34, 102400
    s_add_u32 s3, s95, 118784
    buffer_load_dwordx4 v4, s[12:15], s3 offen nt lds
    s_add_u32 m0, s34, 106496
    s_add_u32 s3, s95, 122880
    buffer_load_dwordx4 v4, s[12:15], s3 offen nt lds
    s_add_u32 m0, s34, 110592
    s_add_u32 s3, s95, 126976
    buffer_load_dwordx4 v4, s[12:15], s3 offen nt lds
    s_add_u32 m0, s34, 114688
    s_add_u32 s3, s96, 131072
    buffer_load_dwordx4 v4, s[12:15], s3 offen nt lds
    s_add_u32 m0, s34, 118784
    s_add_u32 s3, s96, 135168
    buffer_load_dwordx4 v4, s[12:15], s3 offen nt lds
    s_add_u32 m0, s34, 122880
    s_add_u32 s3, s96, 139264
    buffer_load_dwordx4 v4, s[12:15], s3 offen nt lds
    s_add_u32 m0, s34, 126976
    s_add_u32 s3, s96, 143360
    buffer_load_dwordx4 v4, s[12:15], s3 offen nt lds
    s_barrier
    s_waitcnt vmcnt(28)
    s_barrier
    s_add_u32 m0, s34, 0
    s_add_u32 s3, s96, 147456
    buffer_load_dwordx4 v4, s[12:15], s3 offen nt lds
    s_add_u32 m0, s34, 4096
    s_add_u32 s3, s96, 151552
    buffer_load_dwordx4 v4, s[12:15], s3 offen nt lds
    s_add_u32 m0, s34, 8192
    s_add_u32 s3, s96, 155648
    buffer_load_dwordx4 v4, s[12:15], s3 offen nt lds
    s_add_u32 m0, s34, 12288
    s_add_u32 s3, s96, 159744
    buffer_load_dwordx4 v4, s[12:15], s3 offen nt lds
    s_waitcnt vmcnt(24)
    s_barrier
    s_waitcnt vmcnt(16)
    s_barrier
    s_add_u32 m0, s34, 16384
    s_add_u32 s3, s96, 163840
    buffer_load_dwordx4 v4, s[12:15], s3 offen nt lds
    s_add_u32 m0, s34, 20480
    s_add_u32 s3, s96, 167936
    buffer_load_dwordx4 v4, s[12:15], s3 offen nt lds
    s_add_u32 m0, s34, 24576
    s_add_u32 s3, s96, 172032
    buffer_load_dwordx4 v4, s[12:15], s3 offen nt lds
    s_add_u32 m0, s34, 28672
    s_add_u32 s3, s96, 176128
    buffer_load_dwordx4 v4, s[12:15], s3 offen nt lds
    s_add_u32 m0, s34, 32768
    s_add_u32 s3, s96, 180224
    buffer_load_dwordx4 v4, s[12:15], s3 offen nt lds
    s_add_u32 m0, s34, 36864
    s_add_u32 s3, s96, 184320
    buffer_load_dwordx4 v4, s[12:15], s3 offen nt lds
    s_add_u32 m0, s34, 40960
    s_add_u32 s3, s96, 188416
    buffer_load_dwordx4 v4, s[12:15], s3 offen nt lds
    s_add_u32 m0, s34, 45056
    s_add_u32 s3, s96, 192512
    buffer_load_dwordx4 v4, s[12:15], s3 offen nt lds
    s_waitcnt vmcnt(16)
    s_barrier
    s_add_u32 m0, s34, 49152
    s_add_u32 s3, s96, 196608
    buffer_load_dwordx4 v4, s[12:15], s3 offen nt lds
    s_add_u32 m0, s34, 53248
    s_add_u32 s3, s96, 200704
    buffer_load_dwordx4 v4, s[12:15], s3 offen nt lds
    s_add_u32 m0, s34, 57344
    s_add_u32 s3, s96, 204800
    buffer_load_dwordx4 v4, s[12:15], s3 offen nt lds
    s_add_u32 m0, s34, 61440
    s_add_u32 s3, s96, 208896
    buffer_load_dwordx4 v4, s[12:15], s3 offen nt lds
    s_add_u32 m0, s34, 131072
    s_add_u32 s3, s96, 212992
    buffer_load_dwordx4 v4, s[12:15], s3 offen nt lds
    s_add_u32 m0, s34, 135168
    s_add_u32 s3, s96, 217088
    buffer_load_dwordx4 v4, s[12:15], s3 offen nt lds
    s_add_u32 m0, s34, 139264
    s_add_u32 s3, s96, 221184
    buffer_load_dwordx4 v4, s[12:15], s3 offen nt lds
    s_add_u32 m0, s34, 143360
    s_add_u32 s3, s96, 225280
    buffer_load_dwordx4 v4, s[12:15], s3 offen nt lds
    s_waitcnt vmcnt(16)
    s_barrier
    s_add_u32 m0, s34, 147456
    s_add_u32 s3, s96, 229376
    buffer_load_dwordx4 v4, s[12:15], s3 offen nt lds
    s_add_u32 m0, s34, 151552
    s_add_u32 s3, s96, 233472
    buffer_load_dwordx4 v4, s[12:15], s3 offen nt lds
    s_add_u32 m0, s34, 155648
    s_add_u32 s3, s96, 237568
    buffer_load_dwordx4 v4, s[12:15], s3 offen nt lds
    s_add_u32 m0, s34, 159744
    s_add_u32 s3, s96, 241664
    buffer_load_dwordx4 v4, s[12:15], s3 offen nt lds
    s_add_u32 m0, s34, 65536
    s_add_u32 s3, s96, 245760
    buffer_load_dwordx4 v4, s[12:15], s3 offen nt lds
    s_add_u32 m0, s34, 69632
    s_add_u32 s3, s96, 249856
    buffer_load_dwordx4 v4, s[12:15], s3 offen nt lds
    s_add_u32 m0, s34, 73728
    s_add_u32 s3, s96, 253952
    buffer_load_dwordx4 v4, s[12:15], s3 offen nt lds
    s_add_u32 m0, s34, 77824
    s_add_u32 s3, s96, 258048
    buffer_load_dwordx4 v4, s[12:15], s3 offen nt lds
    s_waitcnt vmcnt(16)
    s_barrier
    s_add_u32 m0, s34, 81920
    s_add_u32 s39, s97, 0
    s_sub_u32 s40, s39, 7
    s_cmp_ge_u32 s39, 7
    s_cselect_b32 s39, s40, s39
    s_lshl_b32 s39, s39, 7
    s_add_u32 s38, s39, s37
    s_add_u32 m0, s34, 81920
    s_add_u32 s3, s38, 0
    buffer_load_dwordx4 v6, s[20:23], s3 offen lds
    s_add_u32 m0, s34, 86016
    s_add_u32 s3, s38, 28672
    buffer_load_dwordx4 v6, s[20:23], s3 offen lds
    s_add_u32 m0, s34, 90112
    s_add_u32 s3, s38, 57344
    buffer_load_dwordx4 v6, s[20:23], s3 offen lds
    s_add_u32 m0, s34, 94208
    s_add_u32 s3, s38, 86016
    buffer_load_dwordx4 v6, s[20:23], s3 offen lds
    s_add_u32 m0, s34, 98304
    s_add_u32 s39, s97, 0
    s_sub_u32 s40, s39, 7
    s_cmp_ge_u32 s39, 7
    s_cselect_b32 s39, s40, s39
    s_lshl_b32 s39, s39, 7
    s_add_u32 s38, s39, s37
    s_add_u32 m0, s34, 98304
    s_add_u32 s3, s38, 114688
    buffer_load_dwordx4 v6, s[20:23], s3 offen lds
    s_add_u32 m0, s34, 102400
    s_add_u32 s3, s38, 143360
    buffer_load_dwordx4 v6, s[20:23], s3 offen lds
    s_add_u32 m0, s34, 106496
    s_add_u32 s3, s38, 172032
    buffer_load_dwordx4 v6, s[20:23], s3 offen lds
    s_add_u32 m0, s34, 110592
    s_add_u32 s3, s38, 200704
    buffer_load_dwordx4 v6, s[20:23], s3 offen lds
    s_waitcnt vmcnt(16)
    s_barrier
    s_add_u32 m0, s34, 114688
    s_add_u32 s39, s97, 1
    s_sub_u32 s40, s39, 7
    s_cmp_ge_u32 s39, 7
    s_cselect_b32 s39, s40, s39
    s_lshl_b32 s39, s39, 7
    s_add_u32 s38, s39, s37
    s_add_u32 m0, s34, 114688
    s_add_u32 s3, s38, 0
    buffer_load_dwordx4 v6, s[20:23], s3 offen lds
    s_add_u32 m0, s34, 118784
    s_add_u32 s3, s38, 28672
    buffer_load_dwordx4 v6, s[20:23], s3 offen lds
    s_add_u32 m0, s34, 122880
    s_add_u32 s3, s38, 57344
    buffer_load_dwordx4 v6, s[20:23], s3 offen lds
    s_add_u32 m0, s34, 126976
    s_add_u32 s3, s38, 86016
    buffer_load_dwordx4 v6, s[20:23], s3 offen lds
    s_add_u32 m0, s34, 0
    s_add_u32 s39, s97, 1
    s_sub_u32 s40, s39, 7
    s_cmp_ge_u32 s39, 7
    s_cselect_b32 s39, s40, s39
    s_lshl_b32 s39, s39, 7
    s_add_u32 s38, s39, s37
    s_add_u32 m0, s34, 0
    s_add_u32 s3, s38, 114688
    buffer_load_dwordx4 v6, s[20:23], s3 offen lds
    s_add_u32 m0, s34, 4096
    s_add_u32 s3, s38, 143360
    buffer_load_dwordx4 v6, s[20:23], s3 offen lds
    s_add_u32 m0, s34, 8192
    s_add_u32 s3, s38, 172032
    buffer_load_dwordx4 v6, s[20:23], s3 offen lds
    s_add_u32 m0, s34, 12288
    s_add_u32 s3, s38, 200704
    buffer_load_dwordx4 v6, s[20:23], s3 offen lds
    s_waitcnt vmcnt(16)
    s_barrier
    s_add_u32 m0, s34, 16384
    s_add_u32 s39, s97, 2
    s_sub_u32 s40, s39, 7
    s_cmp_ge_u32 s39, 7
    s_cselect_b32 s39, s40, s39
    s_lshl_b32 s39, s39, 7
    s_add_u32 s38, s39, s37
    s_add_u32 m0, s34, 16384
    s_add_u32 s3, s38, 0
    buffer_load_dwordx4 v6, s[20:23], s3 offen lds
    s_add_u32 m0, s34, 20480
    s_add_u32 s3, s38, 28672
    buffer_load_dwordx4 v6, s[20:23], s3 offen lds
    s_add_u32 m0, s34, 24576
    s_add_u32 s3, s38, 57344
    buffer_load_dwordx4 v6, s[20:23], s3 offen lds
    s_add_u32 m0, s34, 28672
    s_add_u32 s3, s38, 86016
    buffer_load_dwordx4 v6, s[20:23], s3 offen lds
    s_add_u32 m0, s34, 32768
    s_add_u32 s39, s97, 2
    s_sub_u32 s40, s39, 7
    s_cmp_ge_u32 s39, 7
    s_cselect_b32 s39, s40, s39
    s_lshl_b32 s39, s39, 7
    s_add_u32 s38, s39, s37
    s_add_u32 m0, s34, 32768
    s_add_u32 s3, s38, 114688
    buffer_load_dwordx4 v6, s[20:23], s3 offen lds
    s_add_u32 m0, s34, 36864
    s_add_u32 s3, s38, 143360
    buffer_load_dwordx4 v6, s[20:23], s3 offen lds
    s_add_u32 m0, s34, 40960
    s_add_u32 s3, s38, 172032
    buffer_load_dwordx4 v6, s[20:23], s3 offen lds
    s_add_u32 m0, s34, 45056
    s_add_u32 s3, s38, 200704
    buffer_load_dwordx4 v6, s[20:23], s3 offen lds
    s_barrier
    s_barrier
    s_barrier
    s_waitcnt vmcnt(16)
    s_barrier
    s_add_u32 m0, s34, 49152
    s_add_u32 s39, s97, 3
    s_sub_u32 s40, s39, 7
    s_cmp_ge_u32 s39, 7
    s_cselect_b32 s39, s40, s39
    s_lshl_b32 s39, s39, 7
    s_add_u32 s38, s39, s37
    s_add_u32 m0, s34, 49152
    s_add_u32 s3, s38, 0
    buffer_load_dwordx4 v6, s[20:23], s3 offen lds
    s_add_u32 m0, s34, 53248
    s_add_u32 s3, s38, 28672
    buffer_load_dwordx4 v6, s[20:23], s3 offen lds
    s_add_u32 m0, s34, 57344
    s_add_u32 s3, s38, 57344
    buffer_load_dwordx4 v6, s[20:23], s3 offen lds
    s_add_u32 m0, s34, 61440
    s_add_u32 s3, s38, 86016
    buffer_load_dwordx4 v6, s[20:23], s3 offen lds
    s_add_u32 m0, s34, 131072
    s_add_u32 s39, s97, 3
    s_sub_u32 s40, s39, 7
    s_cmp_ge_u32 s39, 7
    s_cselect_b32 s39, s40, s39
    s_lshl_b32 s39, s39, 7
    s_add_u32 s38, s39, s37
    s_add_u32 m0, s34, 131072
    s_add_u32 s3, s38, 114688
    buffer_load_dwordx4 v6, s[20:23], s3 offen lds
    s_add_u32 m0, s34, 135168
    s_add_u32 s3, s38, 143360
    buffer_load_dwordx4 v6, s[20:23], s3 offen lds
    s_add_u32 m0, s34, 139264
    s_add_u32 s3, s38, 172032
    buffer_load_dwordx4 v6, s[20:23], s3 offen lds
    s_add_u32 m0, s34, 143360
    s_add_u32 s3, s38, 200704
    buffer_load_dwordx4 v6, s[20:23], s3 offen lds
    s_waitcnt vmcnt(16)
    s_barrier
    s_add_u32 m0, s34, 147456
    s_add_u32 s39, s97, 4
    s_sub_u32 s40, s39, 7
    s_cmp_ge_u32 s39, 7
    s_cselect_b32 s39, s40, s39
    s_lshl_b32 s39, s39, 7
    s_add_u32 s38, s39, s37
    s_add_u32 m0, s34, 147456
    s_add_u32 s3, s38, 0
    buffer_load_dwordx4 v6, s[20:23], s3 offen lds
    s_add_u32 m0, s34, 151552
    s_add_u32 s3, s38, 28672
    buffer_load_dwordx4 v6, s[20:23], s3 offen lds
    s_add_u32 m0, s34, 155648
    s_add_u32 s3, s38, 57344
    buffer_load_dwordx4 v6, s[20:23], s3 offen lds
    s_add_u32 m0, s34, 159744
    s_add_u32 s3, s38, 86016
    buffer_load_dwordx4 v6, s[20:23], s3 offen lds
    s_add_u32 m0, s34, 65536
    s_add_u32 s39, s97, 4
    s_sub_u32 s40, s39, 7
    s_cmp_ge_u32 s39, 7
    s_cselect_b32 s39, s40, s39
    s_lshl_b32 s39, s39, 7
    s_add_u32 s38, s39, s37
    s_add_u32 m0, s34, 65536
    s_add_u32 s3, s38, 114688
    buffer_load_dwordx4 v6, s[20:23], s3 offen lds
    s_add_u32 m0, s34, 69632
    s_add_u32 s3, s38, 143360
    buffer_load_dwordx4 v6, s[20:23], s3 offen lds
    s_add_u32 m0, s34, 73728
    s_add_u32 s3, s38, 172032
    buffer_load_dwordx4 v6, s[20:23], s3 offen lds
    s_add_u32 m0, s34, 77824
    s_add_u32 s3, s38, 200704
    buffer_load_dwordx4 v6, s[20:23], s3 offen lds
    s_waitcnt vmcnt(16)
    s_barrier
    s_add_u32 m0, s34, 81920
    s_add_u32 s39, s97, 5
    s_sub_u32 s40, s39, 7
    s_cmp_ge_u32 s39, 7
    s_cselect_b32 s39, s40, s39
    s_lshl_b32 s39, s39, 7
    s_add_u32 s38, s39, s37
    s_add_u32 m0, s34, 81920
    s_add_u32 s3, s38, 0
    buffer_load_dwordx4 v6, s[20:23], s3 offen lds
    s_add_u32 m0, s34, 86016
    s_add_u32 s3, s38, 28672
    buffer_load_dwordx4 v6, s[20:23], s3 offen lds
    s_add_u32 m0, s34, 90112
    s_add_u32 s3, s38, 57344
    buffer_load_dwordx4 v6, s[20:23], s3 offen lds
    s_add_u32 m0, s34, 94208
    s_add_u32 s3, s38, 86016
    buffer_load_dwordx4 v6, s[20:23], s3 offen lds
    s_add_u32 m0, s34, 98304
    s_add_u32 s39, s97, 5
    s_sub_u32 s40, s39, 7
    s_cmp_ge_u32 s39, 7
    s_cselect_b32 s39, s40, s39
    s_lshl_b32 s39, s39, 7
    s_add_u32 s38, s39, s37
    s_add_u32 m0, s34, 98304
    s_add_u32 s3, s38, 114688
    buffer_load_dwordx4 v6, s[20:23], s3 offen lds
    s_add_u32 m0, s34, 102400
    s_add_u32 s3, s38, 143360
    buffer_load_dwordx4 v6, s[20:23], s3 offen lds
    s_add_u32 m0, s34, 106496
    s_add_u32 s3, s38, 172032
    buffer_load_dwordx4 v6, s[20:23], s3 offen lds
    s_add_u32 m0, s34, 110592
    s_add_u32 s3, s38, 200704
    buffer_load_dwordx4 v6, s[20:23], s3 offen lds
    s_waitcnt vmcnt(16)
    s_barrier
    s_add_u32 m0, s34, 114688
    s_add_u32 s39, s97, 6
    s_sub_u32 s40, s39, 7
    s_cmp_ge_u32 s39, 7
    s_cselect_b32 s39, s40, s39
    s_lshl_b32 s39, s39, 7
    s_add_u32 s38, s39, s37
    s_add_u32 m0, s34, 114688
    s_add_u32 s3, s38, 0
    buffer_load_dwordx4 v6, s[20:23], s3 offen lds
    s_add_u32 m0, s34, 118784
    s_add_u32 s3, s38, 28672
    buffer_load_dwordx4 v6, s[20:23], s3 offen lds
    s_add_u32 m0, s34, 122880
    s_add_u32 s3, s38, 57344
    buffer_load_dwordx4 v6, s[20:23], s3 offen lds
    s_add_u32 m0, s34, 126976
    s_add_u32 s3, s38, 86016
    buffer_load_dwordx4 v6, s[20:23], s3 offen lds
    s_add_u32 m0, s34, 0
    s_add_u32 s39, s97, 6
    s_sub_u32 s40, s39, 7
    s_cmp_ge_u32 s39, 7
    s_cselect_b32 s39, s40, s39
    s_lshl_b32 s39, s39, 7
    s_add_u32 s38, s39, s37
    s_add_u32 m0, s34, 0
    s_add_u32 s3, s38, 114688
    buffer_load_dwordx4 v6, s[20:23], s3 offen lds
    s_add_u32 m0, s34, 4096
    s_add_u32 s3, s38, 143360
    buffer_load_dwordx4 v6, s[20:23], s3 offen lds
    s_add_u32 m0, s34, 8192
    s_add_u32 s3, s38, 172032
    buffer_load_dwordx4 v6, s[20:23], s3 offen lds
    s_add_u32 m0, s34, 12288
    s_add_u32 s3, s38, 200704
    buffer_load_dwordx4 v6, s[20:23], s3 offen lds
    s_waitcnt vmcnt(16)
    s_barrier
    s_waitcnt vmcnt(8)
    s_barrier
    s_waitcnt vmcnt(0)
    s_barrier
    s_endpgm
.globl reduce_kernel
.p2align 8
.type reduce_kernel,@function
reduce_kernel:
    s_cmp_ge_u32 s2, 224
    s_cbranch_scc1 reduce_end
    s_load_dwordx2 s[4:5], s[0:1], 40
    s_load_dwordx2 s[6:7], s[0:1], 56
    v_and_b32 v1, 63, v0
    v_lshrrev_b32 v2, 6, v0
    s_nop 0
    v_readfirstlane_b32 s3, v2
    s_lshl_b32 s8, s2, 2
    s_add_u32 s8, s8, s3
    s_and_b32 s9, s8, 1
    s_lshr_b32 s10, s8, 1
    s_mul_i32 s11, s10, 9363
    s_lshr_b32 s11, s11, 16
    s_mul_i32 s12, s11, 7
    s_sub_u32 s12, s10, s12
    s_waitcnt lgkmcnt(0)
    s_mov_b32 s16, s6
    s_and_b32 s17, s7, 0xffff
    s_mov_b32 s18, 14680064
    s_mov_b32 s19, 0x20000
    s_mov_b32 s20, s4
    s_and_b32 s21, s5, 0xffff
    s_mov_b32 s22, 917504
    s_mov_b32 s23, 0x20000
    s_lshl_b32 s13, s8, 10
    v_lshlrev_b32 v3, 4, v1
    buffer_load_dwordx4 v[8:11], v3, s[16:19], s13 offen
    s_add_u32 s13, s13, 917504
    buffer_load_dwordx4 v[12:15], v3, s[16:19], s13 offen
    s_add_u32 s13, s13, 917504
    buffer_load_dwordx4 v[16:19], v3, s[16:19], s13 offen
    s_add_u32 s13, s13, 917504
    buffer_load_dwordx4 v[20:23], v3, s[16:19], s13 offen
    s_add_u32 s13, s13, 917504
    buffer_load_dwordx4 v[24:27], v3, s[16:19], s13 offen
    s_add_u32 s13, s13, 917504
    buffer_load_dwordx4 v[28:31], v3, s[16:19], s13 offen
    s_add_u32 s13, s13, 917504
    buffer_load_dwordx4 v[32:35], v3, s[16:19], s13 offen
    s_add_u32 s13, s13, 917504
    buffer_load_dwordx4 v[36:39], v3, s[16:19], s13 offen
    s_add_u32 s13, s13, 917504
    buffer_load_dwordx4 v[40:43], v3, s[16:19], s13 offen
    s_add_u32 s13, s13, 917504
    buffer_load_dwordx4 v[44:47], v3, s[16:19], s13 offen
    s_add_u32 s13, s13, 917504
    buffer_load_dwordx4 v[48:51], v3, s[16:19], s13 offen
    s_add_u32 s13, s13, 917504
    buffer_load_dwordx4 v[52:55], v3, s[16:19], s13 offen
    s_add_u32 s13, s13, 917504
    buffer_load_dwordx4 v[56:59], v3, s[16:19], s13 offen
    s_add_u32 s13, s13, 917504
    buffer_load_dwordx4 v[60:63], v3, s[16:19], s13 offen
    s_add_u32 s13, s13, 917504
    buffer_load_dwordx4 v[64:67], v3, s[16:19], s13 offen
    s_add_u32 s13, s13, 917504
    buffer_load_dwordx4 v[68:71], v3, s[16:19], s13 offen
    s_lshr_b32 s24, s11, 1
    s_lshl_b32 s24, s24, 5
    s_and_b32 s25, s11, 1
    s_lshl_b32 s26, s12, 1
    s_add_u32 s26, s26, s25
    s_lshl_b32 s26, s26, 5
    s_lshl_b32 s27, s9, 4
    s_add_u32 s26, s26, s27
    s_mul_i32 s24, s24, 896
    s_lshl_b32 s26, s26, 1
    s_add_u32 s24, s24, s26
    v_and_b32 v4, 31, v1
    v_mul_u32_u24 v4, 896, v4
    v_lshrrev_b32 v5, 5, v1
    v_lshl_add_u32 v4, v5, 4, v4
    s_waitcnt vmcnt(15)
    v_lshlrev_b32 v80, 16, v8
    v_and_b32 v81, 0xffff0000, v8
    v_lshlrev_b32 v82, 16, v9
    v_and_b32 v83, 0xffff0000, v9
    v_lshlrev_b32 v84, 16, v10
    v_and_b32 v85, 0xffff0000, v10
    v_lshlrev_b32 v86, 16, v11
    v_and_b32 v87, 0xffff0000, v11
    s_waitcnt vmcnt(14)
    v_lshlrev_b32 v88, 16, v12
    v_and_b32 v89, 0xffff0000, v12
    v_add_f32 v80, v80, v88
    v_add_f32 v81, v81, v89
    v_lshlrev_b32 v88, 16, v13
    v_and_b32 v89, 0xffff0000, v13
    v_add_f32 v82, v82, v88
    v_add_f32 v83, v83, v89
    v_lshlrev_b32 v88, 16, v14
    v_and_b32 v89, 0xffff0000, v14
    v_add_f32 v84, v84, v88
    v_add_f32 v85, v85, v89
    v_lshlrev_b32 v88, 16, v15
    v_and_b32 v89, 0xffff0000, v15
    v_add_f32 v86, v86, v88
    v_add_f32 v87, v87, v89
    s_waitcnt vmcnt(13)
    v_lshlrev_b32 v88, 16, v16
    v_and_b32 v89, 0xffff0000, v16
    v_add_f32 v80, v80, v88
    v_add_f32 v81, v81, v89
    v_lshlrev_b32 v88, 16, v17
    v_and_b32 v89, 0xffff0000, v17
    v_add_f32 v82, v82, v88
    v_add_f32 v83, v83, v89
    v_lshlrev_b32 v88, 16, v18
    v_and_b32 v89, 0xffff0000, v18
    v_add_f32 v84, v84, v88
    v_add_f32 v85, v85, v89
    v_lshlrev_b32 v88, 16, v19
    v_and_b32 v89, 0xffff0000, v19
    v_add_f32 v86, v86, v88
    v_add_f32 v87, v87, v89
    s_waitcnt vmcnt(12)
    v_lshlrev_b32 v88, 16, v20
    v_and_b32 v89, 0xffff0000, v20
    v_add_f32 v80, v80, v88
    v_add_f32 v81, v81, v89
    v_lshlrev_b32 v88, 16, v21
    v_and_b32 v89, 0xffff0000, v21
    v_add_f32 v82, v82, v88
    v_add_f32 v83, v83, v89
    v_lshlrev_b32 v88, 16, v22
    v_and_b32 v89, 0xffff0000, v22
    v_add_f32 v84, v84, v88
    v_add_f32 v85, v85, v89
    v_lshlrev_b32 v88, 16, v23
    v_and_b32 v89, 0xffff0000, v23
    v_add_f32 v86, v86, v88
    v_add_f32 v87, v87, v89
    s_waitcnt vmcnt(11)
    v_lshlrev_b32 v88, 16, v24
    v_and_b32 v89, 0xffff0000, v24
    v_add_f32 v80, v80, v88
    v_add_f32 v81, v81, v89
    v_lshlrev_b32 v88, 16, v25
    v_and_b32 v89, 0xffff0000, v25
    v_add_f32 v82, v82, v88
    v_add_f32 v83, v83, v89
    v_lshlrev_b32 v88, 16, v26
    v_and_b32 v89, 0xffff0000, v26
    v_add_f32 v84, v84, v88
    v_add_f32 v85, v85, v89
    v_lshlrev_b32 v88, 16, v27
    v_and_b32 v89, 0xffff0000, v27
    v_add_f32 v86, v86, v88
    v_add_f32 v87, v87, v89
    s_waitcnt vmcnt(10)
    v_lshlrev_b32 v88, 16, v28
    v_and_b32 v89, 0xffff0000, v28
    v_add_f32 v80, v80, v88
    v_add_f32 v81, v81, v89
    v_lshlrev_b32 v88, 16, v29
    v_and_b32 v89, 0xffff0000, v29
    v_add_f32 v82, v82, v88
    v_add_f32 v83, v83, v89
    v_lshlrev_b32 v88, 16, v30
    v_and_b32 v89, 0xffff0000, v30
    v_add_f32 v84, v84, v88
    v_add_f32 v85, v85, v89
    v_lshlrev_b32 v88, 16, v31
    v_and_b32 v89, 0xffff0000, v31
    v_add_f32 v86, v86, v88
    v_add_f32 v87, v87, v89
    s_waitcnt vmcnt(9)
    v_lshlrev_b32 v88, 16, v32
    v_and_b32 v89, 0xffff0000, v32
    v_add_f32 v80, v80, v88
    v_add_f32 v81, v81, v89
    v_lshlrev_b32 v88, 16, v33
    v_and_b32 v89, 0xffff0000, v33
    v_add_f32 v82, v82, v88
    v_add_f32 v83, v83, v89
    v_lshlrev_b32 v88, 16, v34
    v_and_b32 v89, 0xffff0000, v34
    v_add_f32 v84, v84, v88
    v_add_f32 v85, v85, v89
    v_lshlrev_b32 v88, 16, v35
    v_and_b32 v89, 0xffff0000, v35
    v_add_f32 v86, v86, v88
    v_add_f32 v87, v87, v89
    s_waitcnt vmcnt(8)
    v_lshlrev_b32 v88, 16, v36
    v_and_b32 v89, 0xffff0000, v36
    v_add_f32 v80, v80, v88
    v_add_f32 v81, v81, v89
    v_lshlrev_b32 v88, 16, v37
    v_and_b32 v89, 0xffff0000, v37
    v_add_f32 v82, v82, v88
    v_add_f32 v83, v83, v89
    v_lshlrev_b32 v88, 16, v38
    v_and_b32 v89, 0xffff0000, v38
    v_add_f32 v84, v84, v88
    v_add_f32 v85, v85, v89
    v_lshlrev_b32 v88, 16, v39
    v_and_b32 v89, 0xffff0000, v39
    v_add_f32 v86, v86, v88
    v_add_f32 v87, v87, v89
    s_waitcnt vmcnt(7)
    v_lshlrev_b32 v88, 16, v40
    v_and_b32 v89, 0xffff0000, v40
    v_add_f32 v80, v80, v88
    v_add_f32 v81, v81, v89
    v_lshlrev_b32 v88, 16, v41
    v_and_b32 v89, 0xffff0000, v41
    v_add_f32 v82, v82, v88
    v_add_f32 v83, v83, v89
    v_lshlrev_b32 v88, 16, v42
    v_and_b32 v89, 0xffff0000, v42
    v_add_f32 v84, v84, v88
    v_add_f32 v85, v85, v89
    v_lshlrev_b32 v88, 16, v43
    v_and_b32 v89, 0xffff0000, v43
    v_add_f32 v86, v86, v88
    v_add_f32 v87, v87, v89
    s_waitcnt vmcnt(6)
    v_lshlrev_b32 v88, 16, v44
    v_and_b32 v89, 0xffff0000, v44
    v_add_f32 v80, v80, v88
    v_add_f32 v81, v81, v89
    v_lshlrev_b32 v88, 16, v45
    v_and_b32 v89, 0xffff0000, v45
    v_add_f32 v82, v82, v88
    v_add_f32 v83, v83, v89
    v_lshlrev_b32 v88, 16, v46
    v_and_b32 v89, 0xffff0000, v46
    v_add_f32 v84, v84, v88
    v_add_f32 v85, v85, v89
    v_lshlrev_b32 v88, 16, v47
    v_and_b32 v89, 0xffff0000, v47
    v_add_f32 v86, v86, v88
    v_add_f32 v87, v87, v89
    s_waitcnt vmcnt(5)
    v_lshlrev_b32 v88, 16, v48
    v_and_b32 v89, 0xffff0000, v48
    v_add_f32 v80, v80, v88
    v_add_f32 v81, v81, v89
    v_lshlrev_b32 v88, 16, v49
    v_and_b32 v89, 0xffff0000, v49
    v_add_f32 v82, v82, v88
    v_add_f32 v83, v83, v89
    v_lshlrev_b32 v88, 16, v50
    v_and_b32 v89, 0xffff0000, v50
    v_add_f32 v84, v84, v88
    v_add_f32 v85, v85, v89
    v_lshlrev_b32 v88, 16, v51
    v_and_b32 v89, 0xffff0000, v51
    v_add_f32 v86, v86, v88
    v_add_f32 v87, v87, v89
    s_waitcnt vmcnt(4)
    v_lshlrev_b32 v88, 16, v52
    v_and_b32 v89, 0xffff0000, v52
    v_add_f32 v80, v80, v88
    v_add_f32 v81, v81, v89
    v_lshlrev_b32 v88, 16, v53
    v_and_b32 v89, 0xffff0000, v53
    v_add_f32 v82, v82, v88
    v_add_f32 v83, v83, v89
    v_lshlrev_b32 v88, 16, v54
    v_and_b32 v89, 0xffff0000, v54
    v_add_f32 v84, v84, v88
    v_add_f32 v85, v85, v89
    v_lshlrev_b32 v88, 16, v55
    v_and_b32 v89, 0xffff0000, v55
    v_add_f32 v86, v86, v88
    v_add_f32 v87, v87, v89
    s_waitcnt vmcnt(3)
    v_lshlrev_b32 v88, 16, v56
    v_and_b32 v89, 0xffff0000, v56
    v_add_f32 v80, v80, v88
    v_add_f32 v81, v81, v89
    v_lshlrev_b32 v88, 16, v57
    v_and_b32 v89, 0xffff0000, v57
    v_add_f32 v82, v82, v88
    v_add_f32 v83, v83, v89
    v_lshlrev_b32 v88, 16, v58
    v_and_b32 v89, 0xffff0000, v58
    v_add_f32 v84, v84, v88
    v_add_f32 v85, v85, v89
    v_lshlrev_b32 v88, 16, v59
    v_and_b32 v89, 0xffff0000, v59
    v_add_f32 v86, v86, v88
    v_add_f32 v87, v87, v89
    s_waitcnt vmcnt(2)
    v_lshlrev_b32 v88, 16, v60
    v_and_b32 v89, 0xffff0000, v60
    v_add_f32 v80, v80, v88
    v_add_f32 v81, v81, v89
    v_lshlrev_b32 v88, 16, v61
    v_and_b32 v89, 0xffff0000, v61
    v_add_f32 v82, v82, v88
    v_add_f32 v83, v83, v89
    v_lshlrev_b32 v88, 16, v62
    v_and_b32 v89, 0xffff0000, v62
    v_add_f32 v84, v84, v88
    v_add_f32 v85, v85, v89
    v_lshlrev_b32 v88, 16, v63
    v_and_b32 v89, 0xffff0000, v63
    v_add_f32 v86, v86, v88
    v_add_f32 v87, v87, v89
    s_waitcnt vmcnt(1)
    v_lshlrev_b32 v88, 16, v64
    v_and_b32 v89, 0xffff0000, v64
    v_add_f32 v80, v80, v88
    v_add_f32 v81, v81, v89
    v_lshlrev_b32 v88, 16, v65
    v_and_b32 v89, 0xffff0000, v65
    v_add_f32 v82, v82, v88
    v_add_f32 v83, v83, v89
    v_lshlrev_b32 v88, 16, v66
    v_and_b32 v89, 0xffff0000, v66
    v_add_f32 v84, v84, v88
    v_add_f32 v85, v85, v89
    v_lshlrev_b32 v88, 16, v67
    v_and_b32 v89, 0xffff0000, v67
    v_add_f32 v86, v86, v88
    v_add_f32 v87, v87, v89
    s_waitcnt vmcnt(0)
    v_lshlrev_b32 v88, 16, v68
    v_and_b32 v89, 0xffff0000, v68
    v_add_f32 v80, v80, v88
    v_add_f32 v81, v81, v89
    v_lshlrev_b32 v88, 16, v69
    v_and_b32 v89, 0xffff0000, v69
    v_add_f32 v82, v82, v88
    v_add_f32 v83, v83, v89
    v_lshlrev_b32 v88, 16, v70
    v_and_b32 v89, 0xffff0000, v70
    v_add_f32 v84, v84, v88
    v_add_f32 v85, v85, v89
    v_lshlrev_b32 v88, 16, v71
    v_and_b32 v89, 0xffff0000, v71
    v_add_f32 v86, v86, v88
    v_add_f32 v87, v87, v89
    v_cvt_pk_bf16_f32 v92, v80, v81
    v_cvt_pk_bf16_f32 v93, v82, v83
    v_cvt_pk_bf16_f32 v94, v84, v85
    v_cvt_pk_bf16_f32 v95, v86, v87
    buffer_store_dwordx4 v[92:95], v4, s[20:23], s24 offen
reduce_end:
    s_endpgm
.section .rodata,"a"
.p2align 6
.amdhsa_kernel attn_kernel
  .amdhsa_next_free_vgpr 256
  .amdhsa_next_free_sgpr 100
  .amdhsa_accum_offset 256
  .amdhsa_group_segment_fixed_size 0
  .amdhsa_kernarg_size 64
  .amdhsa_user_sgpr_count 2
  .amdhsa_user_sgpr_kernarg_segment_ptr 1
  .amdhsa_system_sgpr_workgroup_id_x 1
.end_amdhsa_kernel
.p2align 6
.amdhsa_kernel reduce_kernel
  .amdhsa_next_free_vgpr 136
  .amdhsa_next_free_sgpr 40
  .amdhsa_accum_offset 136
  .amdhsa_group_segment_fixed_size 0
  .amdhsa_kernarg_size 64
  .amdhsa_user_sgpr_count 2
  .amdhsa_user_sgpr_kernarg_segment_ptr 1
  .amdhsa_system_sgpr_workgroup_id_x 1
.end_amdhsa_kernel
```
